```python
import torch

def _softmax(x, axis=-1):
    return torch.softmax(x, dim=axis)
def _gelu(x):
    return torch.nn.functional.gelu(x, approximate="tanh")
def _silu(x):
    return torch.nn.functional.silu(x)
def _sigmoid(x):
    return torch.sigmoid(x)
def _layernorm(x, axis=-1, eps=1e-5):
    m = x.mean(dim=axis, keepdim=True)
    v = x.var(dim=axis, keepdim=True, unbiased=False)
    return (x - m) / torch.sqrt(v + eps)
def _scatter_add(tgt, idx, src, axis=0):
    return tgt.clone().index_add_(axis, idx, src)
def _segment_sum(src, seg, n):
    out = torch.zeros((n,) + src.shape[1:], dtype=src.dtype)
    return out.index_add_(0, seg, src)
def _pad(x, pw):
    flat = tuple(v for pair in reversed(pw) for v in pair)
    return torch.nn.functional.pad(x, flat)

kernel_name = 'parallel_sum__linear_kernel_hedgehog__glu_gated_bilinear__prompt'

def setup_inputs():

    _w = (lambda a: (lambda t: t.to(torch.bfloat16) if t.is_floating_point() else t)(torch.as_tensor(a)))
    def _A_setup():
        B, S, D, H = 1, 2048, 640, 32
        Dh = D // H
        return {
            "x": _w((lambda *s: torch.randn(*s, dtype=torch.bfloat16) * 0.05)(B, S, D)),
            "wqkv": _w((lambda *s: torch.randn(*s, dtype=torch.bfloat16) * 0.2)(D, 3 * D)),
            "w_phi": _w((lambda *s: torch.randn(*s, dtype=torch.bfloat16) * 0.2)(H, Dh, Dh) * (Dh ** -0.5)),
            "wo": _w((lambda *s: torch.randn(*s, dtype=torch.bfloat16) * 0.05)(D, D)),
        }
    _A_in = _A_setup()

    def _B_setup():
        B, S, D, F = 1, 2048, 640, 1536
        return {
            "x": _w((lambda *s: torch.randn(*s, dtype=torch.bfloat16) * 0.05)(B, S, D)),
            "w_gate": _w((lambda *s: torch.randn(*s, dtype=torch.bfloat16) * 0.4)(D, F) * (D ** -0.5)),
            "w_up": _w((lambda *s: torch.randn(*s, dtype=torch.bfloat16) * 0.4)(D, F) * (D ** -0.5)),
            "w_down": _w((lambda *s: torch.randn(*s, dtype=torch.bfloat16) * 0.4)(F, D) * (F ** -0.5)),
        }
    _B_in = _B_setup()

    return {
        "A_x": _A_in["x"],
        "A_wqkv": _A_in["wqkv"],
        "A_w_phi": _A_in["w_phi"],
        "A_wo": _A_in["wo"],
        "B_x": _B_in["x"],
        "B_w_gate": _B_in["w_gate"],
        "B_w_up": _B_in["w_up"],
        "B_w_down": _B_in["w_down"],
    }

def reference(A_x, A_wqkv, A_w_phi, A_wo, B_x, B_w_gate, B_w_up, B_w_down):
    def _A_ref(x, wqkv, w_phi, wo):
        B, S, D = x.shape
        H = 32; Dh = D // H
        qkv = (lambda x, *d: x.permute(*d))((x @ wqkv).reshape(B, S, 3, H, Dh), 2, 0, 3, 1, 4)
        q, k, v = qkv[0], qkv[1], qkv[2]
        pq = torch.einsum("bhsd,hdf->bhsf", q, w_phi)
        pk = torch.einsum("bhsd,hdf->bhsf", k, w_phi)
        phi_q = torch.concatenate([_softmax(pq, axis=-1), _softmax(-pq, axis=-1)], axis=-1)
        phi_k = torch.concatenate([_softmax(pk, axis=-1), _softmax(-pk, axis=-1)], axis=-1)
        kv = torch.einsum("bhsf,bhsd->bhfd", phi_k, v)
        z  = torch.einsum("bhsf->bhf", phi_k)
        num = torch.einsum("bhqf,bhfd->bhqd", phi_q, kv)
        den = torch.einsum("bhqf,bhf->bhq", phi_q, z)[..., None] + 1e-6
        o = num / den
        return (lambda x, *d: x.permute(*d))(o, 0, 2, 1, 3).reshape(B, S, D) @ wo

    def _B_ref(x, w_gate, w_up, w_down):
        g = torch.einsum("bsd,df->bsf", x, w_gate)
        u = torch.einsum("bsd,df->bsf", x, w_up)
        h = g * u
        return torch.einsum("bsf,fd->bsd", h, w_down)

    x = A_x
    xn = _layernorm(x, axis=-1)
    return x + _A_ref(xn, A_wqkv, A_w_phi, A_wo) + _B_ref(xn, B_w_gate, B_w_up, B_w_down)
```

```asm
; @launch grid=(256,1,1) block=(768,1,1) lds=163840
.amdgcn_target "amdgcn-amd-amdhsa--gfx950"
.text
.globl parallel_sum__linear_kernel_hedgehog__glu_gated_bilinear__prompt_kernel
.p2align 8
.type parallel_sum__linear_kernel_hedgehog__glu_gated_bilinear__prompt_kernel,@function
parallel_sum__linear_kernel_hedgehog__glu_gated_bilinear__prompt_kernel:
  s_cmp_ge_u32 s2, 256
  s_cbranch_scc1 L_exit
  s_load_dwordx16 s[16:31], s[0:1], 0
  s_load_dwordx4 s[32:35], s[0:1], 64
  s_load_dwordx2 s[36:37], s[0:1], 80
  s_getpc_b64 s[14:15]
L_pcref:
  v_lshrrev_b32 v1, 6, v0
  v_and_b32 v0, 63, v0
  v_readfirstlane_b32 s3, v1
  s_lshr_b32 s13, s2, 3
  s_cmp_lt_u32 s13, 8
  s_cselect_b32 s12, s3, 1
  s_cmp_eq_u32 s12, 0
  s_cbranch_scc0 L_nopf
  s_lshl_b32 s12, s13, 13
  v_lshl_add_u32 v1, v0, 7, s12
  global_load_dword v166, v1, s[14:15]
L_nopf:
  s_and_b32 s12, s2, 7
  s_and_b32 s14, s12, 1
  s_lshl_b32 s14, s14, 3
  s_and_b32 s15, s13, 7
  s_add_u32 s4, s14, s15
  s_lshr_b32 s14, s13, 3
  s_lshr_b32 s6, s14, 1
  s_and_b32 s14, s14, 1
  s_lshr_b32 s15, s12, 1
  s_lshl_b32 s5, s15, 1
  s_add_u32 s5, s5, s14
  s_lshl_b32 s7, s15, 3
  s_and_b32 s14, s13, 7
  s_add_u32 s7, s7, s14
  s_and_b32 s8, s12, 1
  s_lshl_b32 s8, s8, 2
  s_lshr_b32 s14, s13, 3
  s_add_u32 s8, s8, s14
  s_mov_b32 s59, 0x3f803f80

  s_cmp_lt_u32 s3, 8
  s_cbranch_scc1 L_compute
  s_sub_u32 s61, s3, 8

  v_lshrrev_b32 v1, 3, v0
  s_lshl_b32 s12, s4, 7
  s_lshl_b32 s13, s61, 5
  s_add_u32 s12, s12, s13
  v_add_u32 v1, s12, v1
  v_mul_u32_u24 v1, 1280, v1
  v_lshrrev_b32 v2, 4, v0
  v_and_b32 v3, 7, v0
  v_xor_b32 v4, v3, v2
  v_xor_b32 v5, 4, v4
  v_lshl_add_u32 v8, v4, 4, v1
  v_lshl_add_u32 v9, v5, 4, v1
  v_add_u32 v9, 9216, v9
  v_add_u32 v10, 18432, v8
  v_add_u32 v11, 18432, v9
  s_lshl_b32 s66, s61, 12
  s_waitcnt lgkmcnt(0)
  s_mov_b32 s40, s16
  s_mov_b32 s41, s17
  s_mov_b32 s42, 2621440
  s_mov_b32 s43, 0x20000
  s_mov_b32 s69, 0
  s_mov_b32 s99, 0
  s_add_u32 m0, s66, 0
  s_mov_b32 s60, s69
  s_add_u32 s69, s69, 128
  s_cmp_eq_u32 s69, 1280
  s_cselect_b32 s69, 0, s69
  buffer_load_dwordx4 v8, s[40:43], s60 offen offset:0 lds
  buffer_load_dwordx4 v9, s[40:43], s60 offen offset:1024 lds
  buffer_load_dwordx4 v10, s[40:43], s60 offen offset:2048 lds
  buffer_load_dwordx4 v11, s[40:43], s60 offen offset:3072 lds
  s_cmp_eq_u32 s6, 0
  s_cbranch_scc0 L_ld_att
  s_cmp_lt_u32 s61, 2
  s_cselect_b32 s44, s26, s28
  s_cselect_b32 s45, s27, s29
  s_mov_b32 s46, 1966080
  s_mov_b32 s47, 0x20000
  s_and_b32 s12, s61, 1
  s_mul_i32 s12, s12, 384
  s_mul_i32 s13, s5, 384
  s_mov_b32 s14, 43691
  s_lshr_b32 s76, s61, 1
  s_mul_i32 s76, s76, 12320
  s_and_b32 s77, s61, 1
  s_mul_i32 s77, s77, 6144
  s_add_u32 s65, s76, s77
  s_add_u32 m0, s65, 49152
  s_mul_i32 s99, s99, 196608
  s_mov_b32 s60, s99
  s_add_u32 s99, s99, 98304
  s_cmp_eq_u32 s99, 1966080
  s_cselect_b32 s99, 0, s99
  v_add_u32 v1, 0, v0
  v_add_u32 v1, s12, v1
  v_mul_lo_u32 v2, v1, s14
  v_lshrrev_b32 v2, 20, v2
  v_mul_u32_u24 v3, 24, v2
  v_sub_u32 v3, v1, v3
  v_bfe_u32 v4, v2, 1, 1
  v_lshlrev_b32 v4, 2, v4
  v_xor_b32 v3, v3, v4
  v_mul_u32_u24 v2, 3072, v2
  v_lshl_add_u32 v2, v3, 4, v2
  v_add_u32 v2, s13, v2
  v_subrev_u32 v12, 0, v2
  buffer_load_dwordx4 v12, s[44:47], s60 offen offset:0 lds
  v_add_u32 v1, 64, v0
  v_add_u32 v1, s12, v1
  v_mul_lo_u32 v2, v1, s14
  v_lshrrev_b32 v2, 20, v2
  v_mul_u32_u24 v3, 24, v2
  v_sub_u32 v3, v1, v3
  v_bfe_u32 v4, v2, 1, 1
  v_lshlrev_b32 v4, 2, v4
  v_xor_b32 v3, v3, v4
  v_mul_u32_u24 v2, 3072, v2
  v_lshl_add_u32 v2, v3, 4, v2
  v_add_u32 v2, s13, v2
  v_subrev_u32 v13, 1024, v2
  buffer_load_dwordx4 v13, s[44:47], s60 offen offset:1024 lds
  v_add_u32 v1, 128, v0
  v_add_u32 v1, s12, v1
  v_mul_lo_u32 v2, v1, s14
  v_lshrrev_b32 v2, 20, v2
  v_mul_u32_u24 v3, 24, v2
  v_sub_u32 v3, v1, v3
  v_bfe_u32 v4, v2, 1, 1
  v_lshlrev_b32 v4, 2, v4
  v_xor_b32 v3, v3, v4
  v_mul_u32_u24 v2, 3072, v2
  v_lshl_add_u32 v2, v3, 4, v2
  v_add_u32 v2, s13, v2
  v_subrev_u32 v14, 2048, v2
  buffer_load_dwordx4 v14, s[44:47], s60 offen offset:2048 lds
  v_add_u32 v1, 192, v0
  v_add_u32 v1, s12, v1
  v_mul_lo_u32 v2, v1, s14
  v_lshrrev_b32 v2, 20, v2
  v_mul_u32_u24 v3, 24, v2
  v_sub_u32 v3, v1, v3
  v_bfe_u32 v4, v2, 1, 1
  v_lshlrev_b32 v4, 2, v4
  v_xor_b32 v3, v3, v4
  v_mul_u32_u24 v2, 3072, v2
  v_lshl_add_u32 v2, v3, 4, v2
  v_add_u32 v2, s13, v2
  v_subrev_u32 v15, 3072, v2
  buffer_load_dwordx4 v15, s[44:47], s60 offen offset:3072 lds
  v_add_u32 v1, 256, v0
  v_add_u32 v1, s12, v1
  v_mul_lo_u32 v2, v1, s14
  v_lshrrev_b32 v2, 20, v2
  v_mul_u32_u24 v3, 24, v2
  v_sub_u32 v3, v1, v3
  v_bfe_u32 v4, v2, 1, 1
  v_lshlrev_b32 v4, 2, v4
  v_xor_b32 v3, v3, v4
  v_mul_u32_u24 v2, 3072, v2
  v_lshl_add_u32 v2, v3, 4, v2
  v_add_u32 v2, s13, v2
  v_subrev_u32 v16, 0, v2
  s_add_u32 m0, s65, 53248
  s_nop 0
  buffer_load_dwordx4 v16, s[44:47], s60 offen offset:0 lds
  v_add_u32 v1, 320, v0
  v_add_u32 v1, s12, v1
  v_mul_lo_u32 v2, v1, s14
  v_lshrrev_b32 v2, 20, v2
  v_mul_u32_u24 v3, 24, v2
  v_sub_u32 v3, v1, v3
  v_bfe_u32 v4, v2, 1, 1
  v_lshlrev_b32 v4, 2, v4
  v_xor_b32 v3, v3, v4
  v_mul_u32_u24 v2, 3072, v2
  v_lshl_add_u32 v2, v3, 4, v2
  v_add_u32 v2, s13, v2
  v_subrev_u32 v17, 1024, v2
  buffer_load_dwordx4 v17, s[44:47], s60 offen offset:1024 lds
  s_add_u32 m0, s65, 73792
  s_mov_b32 s60, s99
  s_add_u32 s99, s99, 98304
  s_cmp_eq_u32 s99, 1966080
  s_cselect_b32 s99, 0, s99
  buffer_load_dwordx4 v12, s[44:47], s60 offen offset:0 lds
  buffer_load_dwordx4 v13, s[44:47], s60 offen offset:1024 lds
  buffer_load_dwordx4 v14, s[44:47], s60 offen offset:2048 lds
  buffer_load_dwordx4 v15, s[44:47], s60 offen offset:3072 lds
  s_add_u32 m0, s65, 77888
  s_nop 0
  buffer_load_dwordx4 v16, s[44:47], s60 offen offset:0 lds
  buffer_load_dwordx4 v17, s[44:47], s60 offen offset:1024 lds
  s_waitcnt vmcnt(6)
  s_barrier
  s_add_u32 m0, s66, 16384
  s_mov_b32 s60, s69
  s_add_u32 s69, s69, 128
  s_cmp_eq_u32 s69, 1280
  s_cselect_b32 s69, 0, s69
  buffer_load_dwordx4 v8, s[40:43], s60 offen offset:0 lds
  buffer_load_dwordx4 v9, s[40:43], s60 offen offset:1024 lds
  buffer_load_dwordx4 v10, s[40:43], s60 offen offset:2048 lds
  buffer_load_dwordx4 v11, s[40:43], s60 offen offset:3072 lds
  s_add_u32 m0, s65, 98432
  s_mov_b32 s60, s99
  s_add_u32 s99, s99, 98304
  s_cmp_eq_u32 s99, 1966080
  s_cselect_b32 s99, 0, s99
  buffer_load_dwordx4 v12, s[44:47], s60 offen offset:0 lds
  buffer_load_dwordx4 v13, s[44:47], s60 offen offset:1024 lds
  buffer_load_dwordx4 v14, s[44:47], s60 offen offset:2048 lds
  buffer_load_dwordx4 v15, s[44:47], s60 offen offset:3072 lds
  s_add_u32 m0, s65, 102528
  s_nop 0
  buffer_load_dwordx4 v16, s[44:47], s60 offen offset:0 lds
  buffer_load_dwordx4 v17, s[44:47], s60 offen offset:1024 lds
  s_add_u32 m0, s65, 123072
  s_mov_b32 s60, s99
  s_add_u32 s99, s99, 98304
  s_cmp_eq_u32 s99, 1966080
  s_cselect_b32 s99, 0, s99
  buffer_load_dwordx4 v12, s[44:47], s60 offen offset:0 lds
  buffer_load_dwordx4 v13, s[44:47], s60 offen offset:1024 lds
  buffer_load_dwordx4 v14, s[44:47], s60 offen offset:2048 lds
  buffer_load_dwordx4 v15, s[44:47], s60 offen offset:3072 lds
  s_add_u32 m0, s65, 127168
  s_nop 0
  buffer_load_dwordx4 v16, s[44:47], s60 offen offset:0 lds
  buffer_load_dwordx4 v17, s[44:47], s60 offen offset:1024 lds
  s_add_u32 m0, s66, 32768
  s_mov_b32 s60, s69
  s_add_u32 s69, s69, 128
  s_cmp_eq_u32 s69, 1280
  s_cselect_b32 s69, 0, s69
  buffer_load_dwordx4 v8, s[40:43], s60 offen offset:0 lds
  buffer_load_dwordx4 v9, s[40:43], s60 offen offset:1024 lds
  buffer_load_dwordx4 v10, s[40:43], s60 offen offset:2048 lds
  buffer_load_dwordx4 v11, s[40:43], s60 offen offset:3072 lds
  v_mov_b32 v25, 0
  global_load_dword v24, v25, s[34:35] sc1
  v_and_b32 v1, 15, v0
  s_lshl_b32 s13, s8, 4
  v_add_u32 v3, s13, v1
  v_add_u32 v3, 128, v3
  s_lshl_b32 s13, s4, 3
  v_and_b32 v4, 7, v1
  v_add_u32 v4, s13, v4
  v_min_u32 v5, 11, v1
  v_lshrrev_b32 v6, 1, v5
  v_and_b32 v5, 1, v5
  s_mul_i32 s13, s5, 3
  v_add_u32 v7, s13, v6
  v_add_u32 v7, 30, v7
  v_add_u32 v2, 21, v7
  v_cmp_le_u32 vcc, 3, v6
  s_nop 1
  v_cndmask_b32 v7, v7, v2, vcc
  v_lshl_add_u32 v7, v7, 1, v5
  v_and_b32 v7, 127, v7
  v_add_u32 v4, 256, v4
  s_nop 0
  v_lshlrev_b32 v3, 7, v3
  v_add_u32 v22, 49152, v3
  s_cmp_lt_u32 s61, 2
  s_cselect_b64 vcc, -1, 0
  v_cndmask_b32 v4, v4, v7, vcc
  v_lshlrev_b32 v4, 7, v4
  v_add_u32 v27, 49152, v4
  s_mov_b32 s48, s36
  s_mov_b32 s49, s37
  s_mov_b32 s50, 2097152
  s_mov_b32 s51, 0x20000
  s_lshl_b32 s12, s61, 6
  v_add_u32 v1, s12, v0
  v_min_u32 v1, 95, v1
  v_mul_u32_u24 v2, 2731, v1
  v_lshrrev_b32 v2, 16, v2
  v_mul_u32_u24 v3, 24, v2
  v_sub_u32 v3, v1, v3
  v_lshrrev_b32 v4, 3, v3
  v_and_b32 v5, 7, v1
  s_mul_i32 s13, s5, 192
  v_lshlrev_b32 v6, 5, v2
  v_lshl_add_u32 v6, v5, 2, v6
  v_lshlrev_b32 v7, 4, v2
  v_and_b32 v3, 3, v5
  v_lshl_add_u32 v7, v3, 2, v7
  v_add_u32 v7, 128, v7
  v_cmp_eq_u32 vcc, 2, v4
  s_nop 1
  v_cndmask_b32 v6, v6, v7, vcc
  v_lshrrev_b32 v7, 2, v5
  v_cndmask_b32 v7, v4, v7, vcc
  v_mul_u32_u24 v7, 1536, v7
  v_add_u32 v6, v6, v7
  v_add_u32 v6, s13, v6
  v_add_u32 v6, 1920, v6
  v_lshlrev_b32 v6, 2, v6
  v_add_u32 v36, 999424, v6
  v_add_u32 v37, 1019392, v6
  v_lshlrev_b32 v1, 4, v1
  v_add_u32 v38, 148736, v1
  s_cmp_lt_u32 s61, 2
  s_cbranch_scc1 L_gs_1
  s_lshl_b32 s13, s4, 10
  s_add_u32 s13, s13, 98304
  v_lshl_add_u32 v36, v0, 4, s13
  v_mov_b32 v37, v36
  v_lshlrev_b32 v1, 4, v0
  v_add_u32 v38, 147712, v1
L_gs_1:
  s_add_u32 s92, s36, 2097152
  s_addc_u32 s93, s37, 0
  s_mov_b32 s94, 2785280
  s_mov_b32 s95, 0x20000
  v_lshlrev_b32 v40, 4, v0
  s_mul_i32 s12, s8, 348160
  s_mul_i32 s13, s61, 61440
  s_add_u32 s86, s12, s13
  s_mul_i32 s13, s61, 25600
  s_add_u32 s87, s12, s13
  s_add_u32 s87, s87, 245760
  s_mul_i32 s88, s61, 10240
  v_add_u32 v41, s88, v40
  s_waitcnt vmcnt(21)
  s_barrier
  s_lshl_b32 s12, s4, 3
  s_add_u32 s12, s12, s5
  s_lshr_b32 s78, s12, 4
  s_and_b32 s12, s12, 15
  s_mul_i32 s12, s12, 22
  s_mul_i32 s13, s61, 6
  s_add_u32 s13, s13, 0
  s_add_u32 s12, s12, s13
  s_cmp_lt_u32 s13, 22
  s_cselect_b32 s79, 1, 0
  s_cmp_lt_u32 s12, 340
  s_cselect_b32 s79, s79, 0
  s_min_u32 s12, s12, 339
  s_mul_i32 s13, s12, 13108
  s_lshr_b32 s13, s13, 16
  s_mul_i32 s14, s13, 5
  s_sub_u32 s14, s12, s14
  s_mul_i32 s15, s78, 340
  s_add_u32 s15, s15, s12
  s_lshl_b32 s15, s15, 10
  s_cmp_eq_u32 s79, 0
  s_cselect_b32 s82, -1, s15
  s_mul_i32 s15, s78, 80
  s_lshl_b32 s76, s14, 4
  s_add_u32 s15, s15, s76
  v_and_b32 v1, 15, v0
  v_add_u32 v1, s15, v1
  v_lshlrev_b32 v1, 1, v1
  v_lshrrev_b32 v2, 4, v0
  v_and_b32 v3, 1, v2
  v_lshlrev_b32 v3, 4, v3
  v_lshrrev_b32 v4, 1, v2
  v_lshl_add_u32 v3, v4, 2, v3
  v_lshlrev_b32 v4, 3, v2
  s_sub_u32 s76, s13, 48
  s_mov_b32 s77, 5120
  s_mov_b32 s54, 819200
  s_cmp_lt_u32 s13, 48
  s_cselect_b32 s52, s30, s22
  s_cselect_b32 s53, s31, s23
  s_cselect_b32 s54, 1966080, s54
  s_mov_b32 s55, 0x20000
  s_cselect_b64 vcc, -1, 0
  s_cselect_b32 s76, s13, s76
  s_cselect_b32 s77, 10240, s77
  v_cndmask_b32 v3, v4, v3, vcc
  s_lshl_b32 s76, s76, 5
  v_add_u32 v3, s76, v3
  v_mul_u32_u24 v3, 1280, v3
  v_add_u32 v3, v3, v1
  v_add_u32 v4, s77, v3
  buffer_load_ushort v44, v3, s[52:55], 0 offen offset:0
  buffer_load_ushort v45, v3, s[52:55], 0 offen offset:1280
  buffer_load_ushort v46, v3, s[52:55], 0 offen offset:2560
  buffer_load_ushort v47, v3, s[52:55], 0 offen offset:3840
  buffer_load_ushort v48, v4, s[52:55], 0 offen offset:0
  buffer_load_ushort v49, v4, s[52:55], 0 offen offset:1280
  buffer_load_ushort v50, v4, s[52:55], 0 offen offset:2560
  buffer_load_ushort v51, v4, s[52:55], 0 offen offset:3840
  s_lshl_b32 s12, s4, 3
  s_add_u32 s12, s12, s5
  s_lshr_b32 s78, s12, 4
  s_and_b32 s12, s12, 15
  s_mul_i32 s12, s12, 22
  s_mul_i32 s13, s61, 6
  s_add_u32 s13, s13, 1
  s_add_u32 s12, s12, s13
  s_cmp_lt_u32 s13, 22
  s_cselect_b32 s79, 1, 0
  s_cmp_lt_u32 s12, 340
  s_cselect_b32 s79, s79, 0
  s_min_u32 s12, s12, 339
  s_mul_i32 s13, s12, 13108
  s_lshr_b32 s13, s13, 16
  s_mul_i32 s14, s13, 5
  s_sub_u32 s14, s12, s14
  s_mul_i32 s15, s78, 340
  s_add_u32 s15, s15, s12
  s_lshl_b32 s15, s15, 10
  s_cmp_eq_u32 s79, 0
  s_cselect_b32 s83, -1, s15
  s_mul_i32 s15, s78, 80
  s_lshl_b32 s76, s14, 4
  s_add_u32 s15, s15, s76
  v_and_b32 v1, 15, v0
  v_add_u32 v1, s15, v1
  v_lshlrev_b32 v1, 1, v1
  v_lshrrev_b32 v2, 4, v0
  v_and_b32 v3, 1, v2
  v_lshlrev_b32 v3, 4, v3
  v_lshrrev_b32 v4, 1, v2
  v_lshl_add_u32 v3, v4, 2, v3
  v_lshlrev_b32 v4, 3, v2
  s_sub_u32 s76, s13, 48
  s_mov_b32 s77, 5120
  s_mov_b32 s54, 819200
  s_cmp_lt_u32 s13, 48
  s_cselect_b32 s52, s30, s22
  s_cselect_b32 s53, s31, s23
  s_cselect_b32 s54, 1966080, s54
  s_mov_b32 s55, 0x20000
  s_cselect_b64 vcc, -1, 0
  s_cselect_b32 s76, s13, s76
  s_cselect_b32 s77, 10240, s77
  v_cndmask_b32 v3, v4, v3, vcc
  s_lshl_b32 s76, s76, 5
  v_add_u32 v3, s76, v3
  v_mul_u32_u24 v3, 1280, v3
  v_add_u32 v3, v3, v1
  v_add_u32 v4, s77, v3
  buffer_load_ushort v52, v3, s[52:55], 0 offen offset:0
  buffer_load_ushort v53, v3, s[52:55], 0 offen offset:1280
  buffer_load_ushort v54, v3, s[52:55], 0 offen offset:2560
  buffer_load_ushort v55, v3, s[52:55], 0 offen offset:3840
  buffer_load_ushort v56, v4, s[52:55], 0 offen offset:0
  buffer_load_ushort v57, v4, s[52:55], 0 offen offset:1280
  buffer_load_ushort v58, v4, s[52:55], 0 offen offset:2560
  buffer_load_ushort v59, v4, s[52:55], 0 offen offset:3840
  s_add_u32 m0, s65, 49152
  s_mov_b32 s60, s99
  s_add_u32 s99, s99, 98304
  s_cmp_eq_u32 s99, 1966080
  s_cselect_b32 s99, 0, s99
  buffer_load_dwordx4 v12, s[44:47], s60 offen offset:0 lds
  buffer_load_dwordx4 v13, s[44:47], s60 offen offset:1024 lds
  buffer_load_dwordx4 v14, s[44:47], s60 offen offset:2048 lds
  buffer_load_dwordx4 v15, s[44:47], s60 offen offset:3072 lds
  s_add_u32 m0, s65, 53248
  s_nop 0
  buffer_load_dwordx4 v16, s[44:47], s60 offen offset:0 lds
  buffer_load_dwordx4 v17, s[44:47], s60 offen offset:1024 lds
  s_waitcnt vmcnt(33)
  s_barrier
  s_lshl_b32 s12, s4, 3
  s_add_u32 s12, s12, s5
  s_lshr_b32 s78, s12, 4
  s_and_b32 s12, s12, 15
  s_mul_i32 s12, s12, 22
  s_mul_i32 s13, s61, 6
  s_add_u32 s13, s13, 2
  s_add_u32 s12, s12, s13
  s_cmp_lt_u32 s13, 22
  s_cselect_b32 s79, 1, 0
  s_cmp_lt_u32 s12, 340
  s_cselect_b32 s79, s79, 0
  s_min_u32 s12, s12, 339
  s_mul_i32 s13, s12, 13108
  s_lshr_b32 s13, s13, 16
  s_mul_i32 s14, s13, 5
  s_sub_u32 s14, s12, s14
  s_mul_i32 s15, s78, 340
  s_add_u32 s15, s15, s12
  s_lshl_b32 s15, s15, 10
  s_cmp_eq_u32 s79, 0
  s_cselect_b32 s84, -1, s15
  s_mul_i32 s15, s78, 80
  s_lshl_b32 s76, s14, 4
  s_add_u32 s15, s15, s76
  v_and_b32 v1, 15, v0
  v_add_u32 v1, s15, v1
  v_lshlrev_b32 v1, 1, v1
  v_lshrrev_b32 v2, 4, v0
  v_and_b32 v3, 1, v2
  v_lshlrev_b32 v3, 4, v3
  v_lshrrev_b32 v4, 1, v2
  v_lshl_add_u32 v3, v4, 2, v3
  v_lshlrev_b32 v4, 3, v2
  s_sub_u32 s76, s13, 48
  s_mov_b32 s77, 5120
  s_mov_b32 s54, 819200
  s_cmp_lt_u32 s13, 48
  s_cselect_b32 s52, s30, s22
  s_cselect_b32 s53, s31, s23
  s_cselect_b32 s54, 1966080, s54
  s_mov_b32 s55, 0x20000
  s_cselect_b64 vcc, -1, 0
  s_cselect_b32 s76, s13, s76
  s_cselect_b32 s77, 10240, s77
  v_cndmask_b32 v3, v4, v3, vcc
  s_lshl_b32 s76, s76, 5
  v_add_u32 v3, s76, v3
  v_mul_u32_u24 v3, 1280, v3
  v_add_u32 v3, v3, v1
  v_add_u32 v4, s77, v3
  buffer_load_ushort v60, v3, s[52:55], 0 offen offset:0
  buffer_load_ushort v61, v3, s[52:55], 0 offen offset:1280
  buffer_load_ushort v62, v3, s[52:55], 0 offen offset:2560
  buffer_load_ushort v63, v3, s[52:55], 0 offen offset:3840
  buffer_load_ushort v64, v4, s[52:55], 0 offen offset:0
  buffer_load_ushort v65, v4, s[52:55], 0 offen offset:1280
  buffer_load_ushort v66, v4, s[52:55], 0 offen offset:2560
  buffer_load_ushort v67, v4, s[52:55], 0 offen offset:3840
  s_lshl_b32 s12, s4, 3
  s_add_u32 s12, s12, s5
  s_lshr_b32 s78, s12, 4
  s_and_b32 s12, s12, 15
  s_mul_i32 s12, s12, 22
  s_mul_i32 s13, s61, 6
  s_add_u32 s13, s13, 3
  s_add_u32 s12, s12, s13
  s_cmp_lt_u32 s13, 22
  s_cselect_b32 s79, 1, 0
  s_cmp_lt_u32 s12, 340
  s_cselect_b32 s79, s79, 0
  s_min_u32 s12, s12, 339
  s_mul_i32 s13, s12, 13108
  s_lshr_b32 s13, s13, 16
  s_mul_i32 s14, s13, 5
  s_sub_u32 s14, s12, s14
  s_mul_i32 s15, s78, 340
  s_add_u32 s15, s15, s12
  s_lshl_b32 s15, s15, 10
  s_cmp_eq_u32 s79, 0
  s_cselect_b32 s85, -1, s15
  s_mul_i32 s15, s78, 80
  s_lshl_b32 s76, s14, 4
  s_add_u32 s15, s15, s76
  v_and_b32 v1, 15, v0
  v_add_u32 v1, s15, v1
  v_lshlrev_b32 v1, 1, v1
  v_lshrrev_b32 v2, 4, v0
  v_and_b32 v3, 1, v2
  v_lshlrev_b32 v3, 4, v3
  v_lshrrev_b32 v4, 1, v2
  v_lshl_add_u32 v3, v4, 2, v3
  v_lshlrev_b32 v4, 3, v2
  s_sub_u32 s76, s13, 48
  s_mov_b32 s77, 5120
  s_mov_b32 s54, 819200
  s_cmp_lt_u32 s13, 48
  s_cselect_b32 s52, s30, s22
  s_cselect_b32 s53, s31, s23
  s_cselect_b32 s54, 1966080, s54
  s_mov_b32 s55, 0x20000
  s_cselect_b64 vcc, -1, 0
  s_cselect_b32 s76, s13, s76
  s_cselect_b32 s77, 10240, s77
  v_cndmask_b32 v3, v4, v3, vcc
  s_lshl_b32 s76, s76, 5
  v_add_u32 v3, s76, v3
  v_mul_u32_u24 v3, 1280, v3
  v_add_u32 v3, v3, v1
  v_add_u32 v4, s77, v3
  buffer_load_ushort v68, v3, s[52:55], 0 offen offset:0
  buffer_load_ushort v69, v3, s[52:55], 0 offen offset:1280
  buffer_load_ushort v70, v3, s[52:55], 0 offen offset:2560
  buffer_load_ushort v71, v3, s[52:55], 0 offen offset:3840
  buffer_load_ushort v72, v4, s[52:55], 0 offen offset:0
  buffer_load_ushort v73, v4, s[52:55], 0 offen offset:1280
  buffer_load_ushort v74, v4, s[52:55], 0 offen offset:2560
  buffer_load_ushort v75, v4, s[52:55], 0 offen offset:3840
  s_add_u32 m0, s66, 0
  s_mov_b32 s60, s69
  s_add_u32 s69, s69, 128
  s_cmp_eq_u32 s69, 1280
  s_cselect_b32 s69, 0, s69
  buffer_load_dwordx4 v8, s[40:43], s60 offen offset:0 lds
  buffer_load_dwordx4 v9, s[40:43], s60 offen offset:1024 lds
  buffer_load_dwordx4 v10, s[40:43], s60 offen offset:2048 lds
  buffer_load_dwordx4 v11, s[40:43], s60 offen offset:3072 lds
  s_add_u32 m0, s65, 73792
  s_mov_b32 s60, s99
  s_add_u32 s99, s99, 98304
  s_cmp_eq_u32 s99, 1966080
  s_cselect_b32 s99, 0, s99
  buffer_load_dwordx4 v12, s[44:47], s60 offen offset:0 lds
  buffer_load_dwordx4 v13, s[44:47], s60 offen offset:1024 lds
  buffer_load_dwordx4 v14, s[44:47], s60 offen offset:2048 lds
  buffer_load_dwordx4 v15, s[44:47], s60 offen offset:3072 lds
  s_add_u32 m0, s65, 77888
  s_nop 0
  buffer_load_dwordx4 v16, s[44:47], s60 offen offset:0 lds
  buffer_load_dwordx4 v17, s[44:47], s60 offen offset:1024 lds
  s_waitcnt vmcnt(53)
  s_barrier
  s_lshl_b32 s12, s4, 3
  s_add_u32 s12, s12, s5
  s_lshr_b32 s78, s12, 4
  s_and_b32 s12, s12, 15
  s_mul_i32 s12, s12, 22
  s_mul_i32 s13, s61, 6
  s_add_u32 s13, s13, 4
  s_add_u32 s12, s12, s13
  s_cmp_lt_u32 s13, 22
  s_cselect_b32 s79, 1, 0
  s_cmp_lt_u32 s12, 340
  s_cselect_b32 s79, s79, 0
  s_min_u32 s12, s12, 339
  s_mul_i32 s13, s12, 13108
  s_lshr_b32 s13, s13, 16
  s_mul_i32 s14, s13, 5
  s_sub_u32 s14, s12, s14
  s_mul_i32 s15, s78, 340
  s_add_u32 s15, s15, s12
  s_lshl_b32 s15, s15, 10
  s_cmp_eq_u32 s79, 0
  s_cselect_b32 s90, -1, s15
  s_mul_i32 s15, s78, 80
  s_lshl_b32 s76, s14, 4
  s_add_u32 s15, s15, s76
  v_and_b32 v1, 15, v0
  v_add_u32 v1, s15, v1
  v_lshlrev_b32 v1, 1, v1
  v_lshrrev_b32 v2, 4, v0
  v_and_b32 v3, 1, v2
  v_lshlrev_b32 v3, 4, v3
  v_lshrrev_b32 v4, 1, v2
  v_lshl_add_u32 v3, v4, 2, v3
  v_lshlrev_b32 v4, 3, v2
  s_sub_u32 s76, s13, 48
  s_mov_b32 s77, 5120
  s_mov_b32 s54, 819200
  s_cmp_lt_u32 s13, 48
  s_cselect_b32 s52, s30, s22
  s_cselect_b32 s53, s31, s23
  s_cselect_b32 s54, 1966080, s54
  s_mov_b32 s55, 0x20000
  s_cselect_b64 vcc, -1, 0
  s_cselect_b32 s76, s13, s76
  s_cselect_b32 s77, 10240, s77
  v_cndmask_b32 v3, v4, v3, vcc
  s_lshl_b32 s76, s76, 5
  v_add_u32 v3, s76, v3
  v_mul_u32_u24 v3, 1280, v3
  v_add_u32 v3, v3, v1
  v_add_u32 v4, s77, v3
  buffer_load_ushort v76, v3, s[52:55], 0 offen offset:0
  buffer_load_ushort v77, v3, s[52:55], 0 offen offset:1280
  buffer_load_ushort v78, v3, s[52:55], 0 offen offset:2560
  buffer_load_ushort v79, v3, s[52:55], 0 offen offset:3840
  buffer_load_ushort v80, v4, s[52:55], 0 offen offset:0
  buffer_load_ushort v81, v4, s[52:55], 0 offen offset:1280
  buffer_load_ushort v82, v4, s[52:55], 0 offen offset:2560
  buffer_load_ushort v83, v4, s[52:55], 0 offen offset:3840
  s_add_u32 m0, s65, 98432
  s_mov_b32 s60, s99
  s_add_u32 s99, s99, 98304
  s_cmp_eq_u32 s99, 1966080
  s_cselect_b32 s99, 0, s99
  buffer_load_dwordx4 v12, s[44:47], s60 offen offset:0 lds
  buffer_load_dwordx4 v13, s[44:47], s60 offen offset:1024 lds
  buffer_load_dwordx4 v14, s[44:47], s60 offen offset:2048 lds
  buffer_load_dwordx4 v15, s[44:47], s60 offen offset:3072 lds
  s_add_u32 m0, s65, 102528
  s_nop 0
  buffer_load_dwordx4 v16, s[44:47], s60 offen offset:0 lds
  buffer_load_dwordx4 v17, s[44:47], s60 offen offset:1024 lds
  s_waitcnt vmcnt(40)
  s_barrier
  s_lshl_b32 s12, s4, 3
  s_add_u32 s12, s12, s5
  s_lshr_b32 s78, s12, 4
  s_and_b32 s12, s12, 15
  s_mul_i32 s12, s12, 22
  s_mul_i32 s13, s61, 6
  s_add_u32 s13, s13, 5
  s_add_u32 s12, s12, s13
  s_cmp_lt_u32 s13, 22
  s_cselect_b32 s79, 1, 0
  s_cmp_lt_u32 s12, 340
  s_cselect_b32 s79, s79, 0
  s_min_u32 s12, s12, 339
  s_mul_i32 s13, s12, 13108
  s_lshr_b32 s13, s13, 16
  s_mul_i32 s14, s13, 5
  s_sub_u32 s14, s12, s14
  s_mul_i32 s15, s78, 340
  s_add_u32 s15, s15, s12
  s_lshl_b32 s15, s15, 10
  s_cmp_eq_u32 s79, 0
  s_cselect_b32 s91, -1, s15
  s_mul_i32 s15, s78, 80
  s_lshl_b32 s76, s14, 4
  s_add_u32 s15, s15, s76
  v_and_b32 v1, 15, v0
  v_add_u32 v1, s15, v1
  v_lshlrev_b32 v1, 1, v1
  v_lshrrev_b32 v2, 4, v0
  v_and_b32 v3, 1, v2
  v_lshlrev_b32 v3, 4, v3
  v_lshrrev_b32 v4, 1, v2
  v_lshl_add_u32 v3, v4, 2, v3
  v_lshlrev_b32 v4, 3, v2
  s_sub_u32 s76, s13, 48
  s_mov_b32 s77, 5120
  s_mov_b32 s54, 819200
  s_cmp_lt_u32 s13, 48
  s_cselect_b32 s52, s30, s22
  s_cselect_b32 s53, s31, s23
  s_cselect_b32 s54, 1966080, s54
  s_mov_b32 s55, 0x20000
  s_cselect_b64 vcc, -1, 0
  s_cselect_b32 s76, s13, s76
  s_cselect_b32 s77, 10240, s77
  v_cndmask_b32 v3, v4, v3, vcc
  s_lshl_b32 s76, s76, 5
  v_add_u32 v3, s76, v3
  v_mul_u32_u24 v3, 1280, v3
  v_add_u32 v3, v3, v1
  v_add_u32 v4, s77, v3
  buffer_load_ushort v84, v3, s[52:55], 0 offen offset:0
  buffer_load_ushort v85, v3, s[52:55], 0 offen offset:1280
  buffer_load_ushort v86, v3, s[52:55], 0 offen offset:2560
  buffer_load_ushort v87, v3, s[52:55], 0 offen offset:3840
  buffer_load_ushort v88, v4, s[52:55], 0 offen offset:0
  buffer_load_ushort v89, v4, s[52:55], 0 offen offset:1280
  buffer_load_ushort v90, v4, s[52:55], 0 offen offset:2560
  buffer_load_ushort v91, v4, s[52:55], 0 offen offset:3840
  s_add_u32 m0, s66, 16384
  s_mov_b32 s60, s69
  s_add_u32 s69, s69, 128
  s_cmp_eq_u32 s69, 1280
  s_cselect_b32 s69, 0, s69
  buffer_load_dwordx4 v8, s[40:43], s60 offen offset:0 lds
  buffer_load_dwordx4 v9, s[40:43], s60 offen offset:1024 lds
  buffer_load_dwordx4 v10, s[40:43], s60 offen offset:2048 lds
  buffer_load_dwordx4 v11, s[40:43], s60 offen offset:3072 lds
  s_add_u32 m0, s65, 123072
  s_mov_b32 s60, s99
  s_add_u32 s99, s99, 98304
  s_cmp_eq_u32 s99, 1966080
  s_cselect_b32 s99, 0, s99
  buffer_load_dwordx4 v12, s[44:47], s60 offen offset:0 lds
  buffer_load_dwordx4 v13, s[44:47], s60 offen offset:1024 lds
  buffer_load_dwordx4 v14, s[44:47], s60 offen offset:2048 lds
  buffer_load_dwordx4 v15, s[44:47], s60 offen offset:3072 lds
  s_add_u32 m0, s65, 127168
  s_nop 0
  buffer_load_dwordx4 v16, s[44:47], s60 offen offset:0 lds
  buffer_load_dwordx4 v17, s[44:47], s60 offen offset:1024 lds
  v_lshl_or_b32 v44, v45, 16, v44
  v_lshl_or_b32 v45, v47, 16, v46
  v_lshl_or_b32 v46, v49, 16, v48
  v_lshl_or_b32 v47, v51, 16, v50
  s_cmp_eq_u32 s82, -1
  s_cselect_b32 s12, 0x40000000, 0
  s_cselect_b32 s13, 0, s82
  v_lshl_add_u32 v5, v0, 4, s12
  buffer_store_dwordx4 v[44:47], v5, s[92:95], s13 offen sc1
  v_lshl_or_b32 v52, v53, 16, v52
  v_lshl_or_b32 v53, v55, 16, v54
  v_lshl_or_b32 v54, v57, 16, v56
  v_lshl_or_b32 v55, v59, 16, v58
  s_cmp_eq_u32 s83, -1
  s_cselect_b32 s12, 0x40000000, 0
  s_cselect_b32 s13, 0, s83
  v_lshl_add_u32 v5, v0, 4, s12
  buffer_store_dwordx4 v[52:55], v5, s[92:95], s13 offen sc1
  s_waitcnt vmcnt(34)
  s_barrier
  s_add_u32 m0, s65, 49152
  s_mov_b32 s60, s99
  s_add_u32 s99, s99, 98304
  s_cmp_eq_u32 s99, 1966080
  s_cselect_b32 s99, 0, s99
  buffer_load_dwordx4 v12, s[44:47], s60 offen offset:0 lds
  buffer_load_dwordx4 v13, s[44:47], s60 offen offset:1024 lds
  buffer_load_dwordx4 v14, s[44:47], s60 offen offset:2048 lds
  buffer_load_dwordx4 v15, s[44:47], s60 offen offset:3072 lds
  s_add_u32 m0, s65, 53248
  s_nop 0
  buffer_load_dwordx4 v16, s[44:47], s60 offen offset:0 lds
  buffer_load_dwordx4 v17, s[44:47], s60 offen offset:1024 lds
  v_lshl_or_b32 v60, v61, 16, v60
  v_lshl_or_b32 v61, v63, 16, v62
  v_lshl_or_b32 v62, v65, 16, v64
  v_lshl_or_b32 v63, v67, 16, v66
  s_cmp_eq_u32 s84, -1
  s_cselect_b32 s12, 0x40000000, 0
  s_cselect_b32 s13, 0, s84
  v_lshl_add_u32 v5, v0, 4, s12
  buffer_store_dwordx4 v[60:63], v5, s[92:95], s13 offen sc1
  v_lshl_or_b32 v68, v69, 16, v68
  v_lshl_or_b32 v69, v71, 16, v70
  v_lshl_or_b32 v70, v73, 16, v72
  v_lshl_or_b32 v71, v75, 16, v74
  s_cmp_eq_u32 s85, -1
  s_cselect_b32 s12, 0x40000000, 0
  s_cselect_b32 s13, 0, s85
  v_lshl_add_u32 v5, v0, 4, s12
  buffer_store_dwordx4 v[68:71], v5, s[92:95], s13 offen sc1
  s_waitcnt vmcnt(28)
  s_barrier
  s_add_u32 m0, s66, 32768
  s_mov_b32 s60, s69
  s_add_u32 s69, s69, 128
  s_cmp_eq_u32 s69, 1280
  s_cselect_b32 s69, 0, s69
  buffer_load_dwordx4 v8, s[40:43], s60 offen offset:0 lds
  buffer_load_dwordx4 v9, s[40:43], s60 offen offset:1024 lds
  buffer_load_dwordx4 v10, s[40:43], s60 offen offset:2048 lds
  buffer_load_dwordx4 v11, s[40:43], s60 offen offset:3072 lds
  s_add_u32 m0, s65, 73792
  s_mov_b32 s60, s99
  s_add_u32 s99, s99, 98304
  s_cmp_eq_u32 s99, 1966080
  s_cselect_b32 s99, 0, s99
  buffer_load_dwordx4 v12, s[44:47], s60 offen offset:0 lds
  buffer_load_dwordx4 v13, s[44:47], s60 offen offset:1024 lds
  buffer_load_dwordx4 v14, s[44:47], s60 offen offset:2048 lds
  buffer_load_dwordx4 v15, s[44:47], s60 offen offset:3072 lds
  s_add_u32 m0, s65, 77888
  s_nop 0
  buffer_load_dwordx4 v16, s[44:47], s60 offen offset:0 lds
  buffer_load_dwordx4 v17, s[44:47], s60 offen offset:1024 lds
  v_lshl_or_b32 v76, v77, 16, v76
  v_lshl_or_b32 v77, v79, 16, v78
  v_lshl_or_b32 v78, v81, 16, v80
  v_lshl_or_b32 v79, v83, 16, v82
  s_cmp_eq_u32 s90, -1
  s_cselect_b32 s12, 0x40000000, 0
  s_cselect_b32 s13, 0, s90
  v_lshl_add_u32 v5, v0, 4, s12
  buffer_store_dwordx4 v[76:79], v5, s[92:95], s13 offen sc1
  s_waitcnt vmcnt(21)
  s_barrier
  s_add_u32 m0, s65, 98432
  s_mov_b32 s60, s99
  s_add_u32 s99, s99, 98304
  s_cmp_eq_u32 s99, 1966080
  s_cselect_b32 s99, 0, s99
  buffer_load_dwordx4 v12, s[44:47], s60 offen offset:0 lds
  buffer_load_dwordx4 v13, s[44:47], s60 offen offset:1024 lds
  buffer_load_dwordx4 v14, s[44:47], s60 offen offset:2048 lds
  buffer_load_dwordx4 v15, s[44:47], s60 offen offset:3072 lds
  s_add_u32 m0, s65, 102528
  s_nop 0
  buffer_load_dwordx4 v16, s[44:47], s60 offen offset:0 lds
  buffer_load_dwordx4 v17, s[44:47], s60 offen offset:1024 lds
  v_lshl_or_b32 v84, v85, 16, v84
  v_lshl_or_b32 v85, v87, 16, v86
  v_lshl_or_b32 v86, v89, 16, v88
  v_lshl_or_b32 v87, v91, 16, v90
  s_cmp_eq_u32 s91, -1
  s_cselect_b32 s12, 0x40000000, 0
  s_cselect_b32 s13, 0, s91
  v_lshl_add_u32 v5, v0, 4, s12
  buffer_store_dwordx4 v[84:87], v5, s[92:95], s13 offen sc1
  s_waitcnt vmcnt(20)
  s_barrier
  s_add_u32 m0, s66, 0
  s_mov_b32 s60, s69
  s_add_u32 s69, s69, 128
  s_cmp_eq_u32 s69, 1280
  s_cselect_b32 s69, 0, s69
  buffer_load_dwordx4 v8, s[40:43], s60 offen offset:0 lds
  buffer_load_dwordx4 v9, s[40:43], s60 offen offset:1024 lds
  buffer_load_dwordx4 v10, s[40:43], s60 offen offset:2048 lds
  buffer_load_dwordx4 v11, s[40:43], s60 offen offset:3072 lds
  s_add_u32 m0, s65, 123072
  s_mov_b32 s60, s99
  s_add_u32 s99, s99, 98304
  s_cmp_eq_u32 s99, 1966080
  s_cselect_b32 s99, 0, s99
  buffer_load_dwordx4 v12, s[44:47], s60 offen offset:0 lds
  buffer_load_dwordx4 v13, s[44:47], s60 offen offset:1024 lds
  buffer_load_dwordx4 v14, s[44:47], s60 offen offset:2048 lds
  buffer_load_dwordx4 v15, s[44:47], s60 offen offset:3072 lds
  s_add_u32 m0, s65, 127168
  s_nop 0
  buffer_load_dwordx4 v16, s[44:47], s60 offen offset:0 lds
  buffer_load_dwordx4 v17, s[44:47], s60 offen offset:1024 lds
  s_waitcnt vmcnt(18)
  s_waitcnt vmcnt(10)
  s_barrier
  v_readfirstlane_b32 s11, v24
  s_nop 0
  s_cmp_eq_u32 s11, 0
  s_cbranch_scc0 L_lt_2
  v_mov_b32 v2, 0
  s_mov_b32 s64, 0
L_tag_3:
  global_load_dword v1, v2, s[34:35] sc1
  s_waitcnt vmcnt(0)
  v_readfirstlane_b32 s11, v1
  s_add_u32 s64, s64, 1
  s_cmp_gt_u32 s64, 200000
  s_cbranch_scc1 L_tagd_4
  s_cmp_eq_u32 s11, 0
  s_cbranch_scc0 L_tagd_4
  s_sleep 1
  s_branch L_tag_3
L_tagd_4:
L_lt_2:
  s_lshl_b32 s12, s4, 3
  s_add_u32 s12, s12, s5
  s_lshl_b32 s12, s12, 7
  s_add_u32 s12, s12, 65536
  v_mov_b32 v1, s12
  v_mov_b32 v2, s11
  s_mov_b64 s[62:63], exec
  s_mov_b64 exec, 1
  global_store_dword v1, v2, s[36:37] sc1
  s_mov_b64 exec, s[62:63]
  s_add_u32 m0, s65, 49152
  s_mov_b32 s60, s99
  s_add_u32 s99, s99, 98304
  s_cmp_eq_u32 s99, 1966080
  s_cselect_b32 s99, 0, s99
  buffer_load_dwordx4 v12, s[44:47], s60 offen offset:0 lds
  buffer_load_dwordx4 v13, s[44:47], s60 offen offset:1024 lds
  buffer_load_dwordx4 v14, s[44:47], s60 offen offset:2048 lds
  buffer_load_dwordx4 v15, s[44:47], s60 offen offset:3072 lds
  s_add_u32 m0, s65, 53248
  s_nop 0
  buffer_load_dwordx4 v16, s[44:47], s60 offen offset:0 lds
  buffer_load_dwordx4 v17, s[44:47], s60 offen offset:1024 lds
  s_barrier
  s_add_u32 m0, s66, 16384
  s_mov_b32 s60, s69
  s_add_u32 s69, s69, 128
  s_cmp_eq_u32 s69, 1280
  s_cselect_b32 s69, 0, s69
  buffer_load_dwordx4 v8, s[40:43], s60 offen offset:0 lds
  buffer_load_dwordx4 v9, s[40:43], s60 offen offset:1024 lds
  buffer_load_dwordx4 v10, s[40:43], s60 offen offset:2048 lds
  buffer_load_dwordx4 v11, s[40:43], s60 offen offset:3072 lds
  s_add_u32 m0, s65, 73792
  s_mov_b32 s60, s99
  s_add_u32 s99, s99, 98304
  s_cmp_eq_u32 s99, 1966080
  s_cselect_b32 s99, 0, s99
  buffer_load_dwordx4 v12, s[44:47], s60 offen offset:0 lds
  buffer_load_dwordx4 v13, s[44:47], s60 offen offset:1024 lds
  buffer_load_dwordx4 v14, s[44:47], s60 offen offset:2048 lds
  buffer_load_dwordx4 v15, s[44:47], s60 offen offset:3072 lds
  s_add_u32 m0, s65, 77888
  s_nop 0
  buffer_load_dwordx4 v16, s[44:47], s60 offen offset:0 lds
  buffer_load_dwordx4 v17, s[44:47], s60 offen offset:1024 lds
  s_waitcnt vmcnt(17)
  s_barrier
  s_add_u32 m0, s65, 98432
  s_mov_b32 s60, s99
  s_add_u32 s99, s99, 98304
  s_cmp_eq_u32 s99, 1966080
  s_cselect_b32 s99, 0, s99
  buffer_load_dwordx4 v12, s[44:47], s60 offen offset:0 lds
  buffer_load_dwordx4 v13, s[44:47], s60 offen offset:1024 lds
  buffer_load_dwordx4 v14, s[44:47], s60 offen offset:2048 lds
  buffer_load_dwordx4 v15, s[44:47], s60 offen offset:3072 lds
  s_add_u32 m0, s65, 102528
  s_nop 0
  buffer_load_dwordx4 v16, s[44:47], s60 offen offset:0 lds
  buffer_load_dwordx4 v17, s[44:47], s60 offen offset:1024 lds
  global_load_dword v26, v27, s[36:37] sc1
  s_waitcnt vmcnt(17)
  s_barrier
  s_add_u32 m0, s66, 32768
  s_mov_b32 s60, s69
  s_add_u32 s69, s69, 128
  s_cmp_eq_u32 s69, 1280
  s_cselect_b32 s69, 0, s69
  buffer_load_dwordx4 v8, s[40:43], s60 offen offset:0 lds
  buffer_load_dwordx4 v9, s[40:43], s60 offen offset:1024 lds
  buffer_load_dwordx4 v10, s[40:43], s60 offen offset:2048 lds
  buffer_load_dwordx4 v11, s[40:43], s60 offen offset:3072 lds
  s_add_u32 m0, s65, 123072
  s_mov_b32 s60, s99
  s_add_u32 s99, s99, 98304
  s_cmp_eq_u32 s99, 1966080
  s_cselect_b32 s99, 0, s99
  buffer_load_dwordx4 v12, s[44:47], s60 offen offset:0 lds
  buffer_load_dwordx4 v13, s[44:47], s60 offen offset:1024 lds
  buffer_load_dwordx4 v14, s[44:47], s60 offen offset:2048 lds
  buffer_load_dwordx4 v15, s[44:47], s60 offen offset:3072 lds
  s_add_u32 m0, s65, 127168
  s_nop 0
  buffer_load_dwordx4 v16, s[44:47], s60 offen offset:0 lds
  buffer_load_dwordx4 v17, s[44:47], s60 offen offset:1024 lds
  global_load_dword v23, v22, s[36:37] sc1
  s_waitcnt vmcnt(18)
  s_waitcnt vmcnt(11)
  s_barrier
  s_add_u32 m0, s65, 49152
  s_mov_b32 s60, s99
  s_add_u32 s99, s99, 98304
  s_cmp_eq_u32 s99, 1966080
  s_cselect_b32 s99, 0, s99
  buffer_load_dwordx4 v12, s[44:47], s60 offen offset:0 lds
  buffer_load_dwordx4 v13, s[44:47], s60 offen offset:1024 lds
  buffer_load_dwordx4 v14, s[44:47], s60 offen offset:2048 lds
  buffer_load_dwordx4 v15, s[44:47], s60 offen offset:3072 lds
  s_add_u32 m0, s65, 53248
  s_nop 0
  buffer_load_dwordx4 v16, s[44:47], s60 offen offset:0 lds
  buffer_load_dwordx4 v17, s[44:47], s60 offen offset:1024 lds
  v_readfirstlane_b32 s11, v24
  s_nop 0
  s_cmp_eq_u32 s11, 0
  s_cbranch_scc1 L_fok_5_slow
  v_cmp_ne_u32 vcc, s11, v26
  s_cbranch_vccz L_fok_5
L_fok_5_slow:
  v_mov_b32 v2, 0
  s_mov_b32 s64, 0
L_tag_6:
  global_load_dword v1, v2, s[34:35] sc1
  s_waitcnt vmcnt(0)
  v_readfirstlane_b32 s11, v1
  s_add_u32 s64, s64, 1
  s_cmp_gt_u32 s64, 200000
  s_cbranch_scc1 L_tagd_7
  s_cmp_eq_u32 s11, 0
  s_cbranch_scc0 L_tagd_7
  s_sleep 1
  s_branch L_tag_6
L_tagd_7:
  v_mov_b32 v24, s11
  s_mov_b32 s64, 0
L_poll_8:
  global_load_dword v1, v27, s[36:37] sc1
  s_waitcnt vmcnt(0)
  v_cmp_ne_u32 vcc, s11, v1
  s_add_u32 s64, s64, 1
  s_cmp_gt_u32 s64, 200000
  s_cbranch_scc1 L_polld_9
  s_cbranch_vccz L_polld_9
  s_sleep 1
  s_branch L_poll_8
L_polld_9:
L_fok_5:
  buffer_load_dwordx4 v[28:31], v36, s[48:51], 0 offen sc1
  buffer_load_dwordx4 v[32:35], v37, s[48:51], 0 offen sc1
  s_barrier
  s_add_u32 m0, s66, 0
  s_mov_b32 s60, s69
  s_add_u32 s69, s69, 128
  s_cmp_eq_u32 s69, 1280
  s_cselect_b32 s69, 0, s69
  buffer_load_dwordx4 v8, s[40:43], s60 offen offset:0 lds
  buffer_load_dwordx4 v9, s[40:43], s60 offen offset:1024 lds
  buffer_load_dwordx4 v10, s[40:43], s60 offen offset:2048 lds
  buffer_load_dwordx4 v11, s[40:43], s60 offen offset:3072 lds
  s_add_u32 m0, s65, 73792
  s_mov_b32 s60, s99
  s_add_u32 s99, s99, 98304
  s_cmp_eq_u32 s99, 1966080
  s_cselect_b32 s99, 0, s99
  buffer_load_dwordx4 v12, s[44:47], s60 offen offset:0 lds
  buffer_load_dwordx4 v13, s[44:47], s60 offen offset:1024 lds
  buffer_load_dwordx4 v14, s[44:47], s60 offen offset:2048 lds
  buffer_load_dwordx4 v15, s[44:47], s60 offen offset:3072 lds
  s_add_u32 m0, s65, 77888
  s_nop 0
  buffer_load_dwordx4 v16, s[44:47], s60 offen offset:0 lds
  buffer_load_dwordx4 v17, s[44:47], s60 offen offset:1024 lds
  s_waitcnt vmcnt(18)
  v_readfirstlane_b32 s11, v24
  s_nop 0
  s_cmp_eq_u32 s11, 0
  s_cbranch_scc1 L_fok_10_slow
  v_cmp_ne_u32 vcc, s11, v23
  s_cbranch_vccz L_fok_10
L_fok_10_slow:
  v_mov_b32 v2, 0
  s_mov_b32 s64, 0
L_tag_11:
  global_load_dword v1, v2, s[34:35] sc1
  s_waitcnt vmcnt(0)
  v_readfirstlane_b32 s11, v1
  s_add_u32 s64, s64, 1
  s_cmp_gt_u32 s64, 200000
  s_cbranch_scc1 L_tagd_12
  s_cmp_eq_u32 s11, 0
  s_cbranch_scc0 L_tagd_12
  s_sleep 1
  s_branch L_tag_11
L_tagd_12:
  v_mov_b32 v24, s11
  s_mov_b32 s64, 0
L_poll_13:
  global_load_dword v1, v22, s[36:37] sc1
  s_waitcnt vmcnt(0)
  v_cmp_ne_u32 vcc, s11, v1
  s_add_u32 s64, s64, 1
  s_cmp_gt_u32 s64, 200000
  s_cbranch_scc1 L_polld_14
  s_cbranch_vccz L_polld_14
  s_sleep 1
  s_branch L_poll_13
L_polld_14:
L_fok_10:
  s_lshr_b32 s12, s2, 3
  s_and_b32 s12, s12, 7
  s_mul_i32 s13, s12, 7680
  s_add_u32 s13, s13, s86
  v_min_u32 v1, 59, v0
  v_lshlrev_b32 v1, 7, v1
  buffer_load_dword v42, v1, s[92:95], s13 offen sc1
  s_mul_i32 s13, s12, 3200
  s_add_u32 s13, s13, s87
  v_min_u32 v1, 24, v0
  v_lshlrev_b32 v1, 7, v1
  buffer_load_dword v43, v1, s[92:95], s13 offen sc1
  s_barrier
  s_add_u32 m0, s65, 98432
  s_mov_b32 s60, s99
  s_add_u32 s99, s99, 98304
  s_cmp_eq_u32 s99, 1966080
  s_cselect_b32 s99, 0, s99
  buffer_load_dwordx4 v12, s[44:47], s60 offen offset:0 lds
  buffer_load_dwordx4 v13, s[44:47], s60 offen offset:1024 lds
  buffer_load_dwordx4 v14, s[44:47], s60 offen offset:2048 lds
  buffer_load_dwordx4 v15, s[44:47], s60 offen offset:3072 lds
  s_add_u32 m0, s65, 102528
  s_nop 0
  buffer_load_dwordx4 v16, s[44:47], s60 offen offset:0 lds
  buffer_load_dwordx4 v17, s[44:47], s60 offen offset:1024 lds
  s_add_u32 s60, s86, 30720
  buffer_load_dwordx4 v[44:47], v40, s[92:95], s60 offen sc1
  s_add_u32 s60, s86, 31744
  buffer_load_dwordx4 v[48:51], v40, s[92:95], s60 offen sc1
  s_add_u32 s60, s86, 32768
  buffer_load_dwordx4 v[52:55], v40, s[92:95], s60 offen sc1
  s_add_u32 s60, s86, 33792
  buffer_load_dwordx4 v[56:59], v40, s[92:95], s60 offen sc1
  s_add_u32 s60, s86, 34816
  buffer_load_dwordx4 v[60:63], v40, s[92:95], s60 offen sc1
  s_waitcnt vmcnt(25)
  s_barrier
  s_add_u32 m0, s65, 123072
  s_mov_b32 s60, s99
  s_add_u32 s99, s99, 98304
  s_cmp_eq_u32 s99, 1966080
  s_cselect_b32 s99, 0, s99
  buffer_load_dwordx4 v12, s[44:47], s60 offen offset:0 lds
  buffer_load_dwordx4 v13, s[44:47], s60 offen offset:1024 lds
  buffer_load_dwordx4 v14, s[44:47], s60 offen offset:2048 lds
  buffer_load_dwordx4 v15, s[44:47], s60 offen offset:3072 lds
  s_add_u32 m0, s65, 127168
  s_nop 0
  buffer_load_dwordx4 v16, s[44:47], s60 offen offset:0 lds
  buffer_load_dwordx4 v17, s[44:47], s60 offen offset:1024 lds
  s_add_u32 s60, s86, 35840
  buffer_load_dwordx4 v[64:67], v40, s[92:95], s60 offen sc1
  s_add_u32 s60, s86, 36864
  buffer_load_dwordx4 v[68:71], v40, s[92:95], s60 offen sc1
  s_add_u32 s60, s86, 37888
  buffer_load_dwordx4 v[72:75], v40, s[92:95], s60 offen sc1
  s_add_u32 s60, s86, 38912
  buffer_load_dwordx4 v[76:79], v40, s[92:95], s60 offen sc1
  s_add_u32 s60, s86, 39936
  buffer_load_dwordx4 v[80:83], v40, s[92:95], s60 offen sc1
  s_waitcnt vmcnt(24)
  s_cmp_ge_u32 s61, 2
  s_cbranch_scc1 L_gf_15
  v_add_f32 v28, v28, v32
  v_add_f32 v29, v29, v33
  v_add_f32 v30, v30, v34
  v_add_f32 v31, v31, v35
L_gf_15:
  ds_write_b128 v38, v[28:31]
  s_waitcnt lgkmcnt(0)
  s_barrier
  s_add_u32 s60, s86, 40960
  buffer_load_dwordx4 v[84:87], v40, s[92:95], s60 offen sc1
  s_add_u32 s60, s86, 41984
  buffer_load_dwordx4 v[88:91], v40, s[92:95], s60 offen sc1
  s_add_u32 s60, s86, 43008
  buffer_load_dwordx4 v[92:95], v40, s[92:95], s60 offen sc1
  s_add_u32 s60, s86, 44032
  buffer_load_dwordx4 v[96:99], v40, s[92:95], s60 offen sc1
  s_add_u32 s60, s86, 45056
  buffer_load_dwordx4 v[100:103], v40, s[92:95], s60 offen sc1
  s_waitcnt vmcnt(21)
  s_barrier
  s_add_u32 s60, s86, 46080
  buffer_load_dwordx4 v[104:107], v40, s[92:95], s60 offen sc1
  s_add_u32 s60, s86, 47104
  buffer_load_dwordx4 v[108:111], v40, s[92:95], s60 offen sc1
  s_add_u32 s60, s86, 48128
  buffer_load_dwordx4 v[112:115], v40, s[92:95], s60 offen sc1
  s_add_u32 s60, s86, 49152
  buffer_load_dwordx4 v[116:119], v40, s[92:95], s60 offen sc1
  s_add_u32 s60, s86, 50176
  buffer_load_dwordx4 v[120:123], v40, s[92:95], s60 offen sc1
  s_waitcnt vmcnt(15)
  s_barrier
  s_add_u32 s60, s86, 51200
  buffer_load_dwordx4 v[124:127], v40, s[92:95], s60 offen sc1
  s_add_u32 s60, s86, 52224
  buffer_load_dwordx4 v[128:131], v40, s[92:95], s60 offen sc1
  s_add_u32 s60, s86, 53248
  buffer_load_dwordx4 v[132:135], v40, s[92:95], s60 offen sc1
  s_add_u32 s60, s86, 54272
  buffer_load_dwordx4 v[136:139], v40, s[92:95], s60 offen sc1
  s_add_u32 s60, s86, 55296
  buffer_load_dwordx4 v[140:143], v40, s[92:95], s60 offen sc1
  s_barrier
  s_add_u32 s60, s86, 56320
  buffer_load_dwordx4 v[144:147], v40, s[92:95], s60 offen sc1
  s_add_u32 s60, s86, 57344
  buffer_load_dwordx4 v[148:151], v40, s[92:95], s60 offen sc1
  s_add_u32 s60, s86, 58368
  buffer_load_dwordx4 v[152:155], v40, s[92:95], s60 offen sc1
  s_add_u32 s60, s86, 59392
  buffer_load_dwordx4 v[156:159], v40, s[92:95], s60 offen sc1
  s_add_u32 s60, s86, 60416
  buffer_load_dwordx4 v[160:163], v40, s[92:95], s60 offen sc1
  s_add_u32 m0, s88, 0
  s_add_u32 s60, s86, 0
  buffer_load_dwordx4 v40, s[92:95], s60 offen offset:0 sc1 lds
  buffer_load_dwordx4 v40, s[92:95], s60 offen offset:1024 sc1 lds
  buffer_load_dwordx4 v40, s[92:95], s60 offen offset:2048 sc1 lds
  buffer_load_dwordx4 v40, s[92:95], s60 offen offset:3072 sc1 lds
  s_add_u32 m0, s88, 4096
  s_add_u32 s60, s86, 4096
  buffer_load_dwordx4 v40, s[92:95], s60 offen offset:0 sc1 lds
  buffer_load_dwordx4 v40, s[92:95], s60 offen offset:1024 sc1 lds
  buffer_load_dwordx4 v40, s[92:95], s60 offen offset:2048 sc1 lds
  buffer_load_dwordx4 v40, s[92:95], s60 offen offset:3072 sc1 lds
  s_add_u32 m0, s88, 8192
  s_add_u32 s60, s86, 8192
  buffer_load_dwordx4 v40, s[92:95], s60 offen offset:0 sc1 lds
  buffer_load_dwordx4 v40, s[92:95], s60 offen offset:1024 sc1 lds
  s_add_u32 m0, s88, 40960
  s_add_u32 s60, s86, 10240
  buffer_load_dwordx4 v40, s[92:95], s60 offen offset:0 sc1 lds
  buffer_load_dwordx4 v40, s[92:95], s60 offen offset:1024 sc1 lds
  buffer_load_dwordx4 v40, s[92:95], s60 offen offset:2048 sc1 lds
  buffer_load_dwordx4 v40, s[92:95], s60 offen offset:3072 sc1 lds
  s_add_u32 m0, s88, 45056
  s_add_u32 s60, s86, 14336
  buffer_load_dwordx4 v40, s[92:95], s60 offen offset:0 sc1 lds
  buffer_load_dwordx4 v40, s[92:95], s60 offen offset:1024 sc1 lds
  buffer_load_dwordx4 v40, s[92:95], s60 offen offset:2048 sc1 lds
  buffer_load_dwordx4 v40, s[92:95], s60 offen offset:3072 sc1 lds
  s_add_u32 m0, s88, 49152
  s_add_u32 s60, s86, 18432
  buffer_load_dwordx4 v40, s[92:95], s60 offen offset:0 sc1 lds
  buffer_load_dwordx4 v40, s[92:95], s60 offen offset:1024 sc1 lds
  s_add_u32 m0, s88, 81920
  s_add_u32 s60, s86, 20480
  buffer_load_dwordx4 v40, s[92:95], s60 offen offset:0 sc1 lds
  buffer_load_dwordx4 v40, s[92:95], s60 offen offset:1024 sc1 lds
  buffer_load_dwordx4 v40, s[92:95], s60 offen offset:2048 sc1 lds
  buffer_load_dwordx4 v40, s[92:95], s60 offen offset:3072 sc1 lds
  s_add_u32 m0, s88, 86016
  s_add_u32 s60, s86, 24576
  buffer_load_dwordx4 v40, s[92:95], s60 offen offset:0 sc1 lds
  buffer_load_dwordx4 v40, s[92:95], s60 offen offset:1024 sc1 lds
  buffer_load_dwordx4 v40, s[92:95], s60 offen offset:2048 sc1 lds
  buffer_load_dwordx4 v40, s[92:95], s60 offen offset:3072 sc1 lds
  s_add_u32 m0, s88, 90112
  s_add_u32 s60, s86, 28672
  buffer_load_dwordx4 v40, s[92:95], s60 offen offset:0 sc1 lds
  buffer_load_dwordx4 v40, s[92:95], s60 offen offset:1024 sc1 lds
  s_waitcnt vmcnt(10)
  s_barrier
  v_add_u32 v42, 122880, v41
  ds_write_b128 v42, v[44:47] offset:0
  ds_write_b128 v42, v[48:51] offset:1024
  ds_write_b128 v42, v[52:55] offset:2048
  ds_write_b128 v42, v[56:59] offset:3072
  ds_write_b128 v42, v[60:63] offset:4096
  ds_write_b128 v42, v[64:67] offset:5120
  ds_write_b128 v42, v[68:71] offset:6144
  ds_write_b128 v42, v[72:75] offset:7168
  ds_write_b128 v42, v[76:79] offset:8192
  ds_write_b128 v42, v[80:83] offset:9216
  s_waitcnt vmcnt(0)
  s_waitcnt lgkmcnt(0)
  s_barrier
  v_add_u32 v42, 0, v41
  ds_write_b128 v42, v[84:87] offset:0
  ds_write_b128 v42, v[88:91] offset:1024
  ds_write_b128 v42, v[92:95] offset:2048
  ds_write_b128 v42, v[96:99] offset:3072
  ds_write_b128 v42, v[100:103] offset:4096
  ds_write_b128 v42, v[104:107] offset:5120
  ds_write_b128 v42, v[108:111] offset:6144
  ds_write_b128 v42, v[112:115] offset:7168
  ds_write_b128 v42, v[116:119] offset:8192
  ds_write_b128 v42, v[120:123] offset:9216
  v_add_u32 v42, 40960, v41
  ds_write_b128 v42, v[124:127] offset:0
  ds_write_b128 v42, v[128:131] offset:1024
  ds_write_b128 v42, v[132:135] offset:2048
  ds_write_b128 v42, v[136:139] offset:3072
  ds_write_b128 v42, v[140:143] offset:4096
  ds_write_b128 v42, v[144:147] offset:5120
  ds_write_b128 v42, v[148:151] offset:6144
  ds_write_b128 v42, v[152:155] offset:7168
  ds_write_b128 v42, v[156:159] offset:8192
  ds_write_b128 v42, v[160:163] offset:9216
  s_waitcnt lgkmcnt(0)
  s_barrier
  s_add_u32 m0, s88, 81920
  s_add_u32 s60, s87, 0
  buffer_load_dwordx4 v40, s[92:95], s60 offen offset:0 sc1 lds
  buffer_load_dwordx4 v40, s[92:95], s60 offen offset:1024 sc1 lds
  buffer_load_dwordx4 v40, s[92:95], s60 offen offset:2048 sc1 lds
  buffer_load_dwordx4 v40, s[92:95], s60 offen offset:3072 sc1 lds
  s_add_u32 m0, s88, 86016
  s_add_u32 s60, s87, 4096
  buffer_load_dwordx4 v40, s[92:95], s60 offen offset:0 sc1 lds
  buffer_load_dwordx4 v40, s[92:95], s60 offen offset:1024 sc1 lds
  buffer_load_dwordx4 v40, s[92:95], s60 offen offset:2048 sc1 lds
  buffer_load_dwordx4 v40, s[92:95], s60 offen offset:3072 sc1 lds
  s_add_u32 m0, s88, 90112
  s_add_u32 s60, s87, 8192
  buffer_load_dwordx4 v40, s[92:95], s60 offen offset:0 sc1 lds
  buffer_load_dwordx4 v40, s[92:95], s60 offen offset:1024 sc1 lds
  s_add_u32 m0, s88, 122880
  s_add_u32 s60, s87, 10240
  buffer_load_dwordx4 v40, s[92:95], s60 offen offset:0 sc1 lds
  buffer_load_dwordx4 v40, s[92:95], s60 offen offset:1024 sc1 lds
  buffer_load_dwordx4 v40, s[92:95], s60 offen offset:2048 sc1 lds
  buffer_load_dwordx4 v40, s[92:95], s60 offen offset:3072 sc1 lds
  s_add_u32 m0, s88, 126976
  s_add_u32 s60, s87, 14336
  buffer_load_dwordx4 v40, s[92:95], s60 offen offset:0 sc1 lds
  buffer_load_dwordx4 v40, s[92:95], s60 offen offset:1024 sc1 lds
  buffer_load_dwordx4 v40, s[92:95], s60 offen offset:2048 sc1 lds
  buffer_load_dwordx4 v40, s[92:95], s60 offen offset:3072 sc1 lds
  s_add_u32 m0, s88, 131072
  s_add_u32 s60, s87, 18432
  buffer_load_dwordx4 v40, s[92:95], s60 offen offset:0 sc1 lds
  buffer_load_dwordx4 v40, s[92:95], s60 offen offset:1024 sc1 lds
  s_waitcnt vmcnt(10)
  s_waitcnt vmcnt(0)
  s_waitcnt lgkmcnt(0)
  s_barrier
  s_add_u32 m0, s88, 0
  s_add_u32 s60, s87, 20480
  buffer_load_dwordx4 v40, s[92:95], s60 offen offset:0 sc1 lds
  buffer_load_dwordx4 v40, s[92:95], s60 offen offset:1024 sc1 lds
  buffer_load_dwordx4 v40, s[92:95], s60 offen offset:2048 sc1 lds
  buffer_load_dwordx4 v40, s[92:95], s60 offen offset:3072 sc1 lds
  s_add_u32 m0, s88, 4096
  s_add_u32 s60, s87, 24576
  buffer_load_dwordx4 v40, s[92:95], s60 offen offset:0 sc1 lds
  s_waitcnt vmcnt(0)
  s_waitcnt lgkmcnt(0)
  s_barrier
  s_barrier
  s_branch L_ld_end
L_ld_att:
  s_mov_b32 s44, s18
  s_mov_b32 s45, s19
  s_mov_b32 s46, 2457600
  s_mov_b32 s47, 0x20000
  s_mul_i32 s13, s5, 160
  s_lshl_b32 s65, s61, 12
  s_add_u32 m0, s65, 49152
  s_mul_i32 s99, s99, 245760
  s_lshl_b32 s12, s61, 3
  s_mov_b32 s60, s99
  s_add_u32 s99, s99, 122880
  s_cmp_eq_u32 s99, 2457600
  s_cselect_b32 s99, 0, s99
  v_lshrrev_b32 v1, 5, v0
  v_add_u32 v1, 0, v1
  v_and_b32 v2, 3, v1
  v_lshlrev_b32 v2, 2, v2
  v_and_b32 v3, 31, v0
  v_xor_b32 v3, v3, v2
  v_add_u32 v1, s12, v1
  v_mul_u32_u24 v1, 3840, v1
  v_min_u32 v4, 9, v3
  v_lshlrev_b32 v4, 4, v4
  v_subrev_u32 v5, 11, v3
  v_lshlrev_b32 v5, 4, v5
  v_add_u32 v5, 1280, v5
  v_min_u32 v6, 30, v3
  v_subrev_u32 v6, 21, v6
  v_lshlrev_b32 v6, 4, v6
  v_add_u32 v6, 2560, v6
  v_cmp_le_u32 vcc, 11, v3
  s_nop 1
  v_cndmask_b32 v4, v4, v5, vcc
  v_cmp_le_u32 vcc, 21, v3
  s_nop 1
  v_cndmask_b32 v4, v4, v6, vcc
  v_add_u32 v1, v1, v4
  v_add_u32 v1, s13, v1
  v_subrev_u32 v12, 0, v1
  buffer_load_dwordx4 v12, s[44:47], s60 offen offset:0 lds
  v_lshrrev_b32 v1, 5, v0
  v_add_u32 v1, 2, v1
  v_and_b32 v2, 3, v1
  v_lshlrev_b32 v2, 2, v2
  v_and_b32 v3, 31, v0
  v_xor_b32 v3, v3, v2
  v_add_u32 v1, s12, v1
  v_mul_u32_u24 v1, 3840, v1
  v_min_u32 v4, 9, v3
  v_lshlrev_b32 v4, 4, v4
  v_subrev_u32 v5, 11, v3
  v_lshlrev_b32 v5, 4, v5
  v_add_u32 v5, 1280, v5
  v_min_u32 v6, 30, v3
  v_subrev_u32 v6, 21, v6
  v_lshlrev_b32 v6, 4, v6
  v_add_u32 v6, 2560, v6
  v_cmp_le_u32 vcc, 11, v3
  s_nop 1
  v_cndmask_b32 v4, v4, v5, vcc
  v_cmp_le_u32 vcc, 21, v3
  s_nop 1
  v_cndmask_b32 v4, v4, v6, vcc
  v_add_u32 v1, v1, v4
  v_add_u32 v1, s13, v1
  v_subrev_u32 v13, 1024, v1
  buffer_load_dwordx4 v13, s[44:47], s60 offen offset:1024 lds
  v_lshrrev_b32 v1, 5, v0
  v_add_u32 v1, 4, v1
  v_and_b32 v2, 3, v1
  v_lshlrev_b32 v2, 2, v2
  v_and_b32 v3, 31, v0
  v_xor_b32 v3, v3, v2
  v_add_u32 v1, s12, v1
  v_mul_u32_u24 v1, 3840, v1
  v_min_u32 v4, 9, v3
  v_lshlrev_b32 v4, 4, v4
  v_subrev_u32 v5, 11, v3
  v_lshlrev_b32 v5, 4, v5
  v_add_u32 v5, 1280, v5
  v_min_u32 v6, 30, v3
  v_subrev_u32 v6, 21, v6
  v_lshlrev_b32 v6, 4, v6
  v_add_u32 v6, 2560, v6
  v_cmp_le_u32 vcc, 11, v3
  s_nop 1
  v_cndmask_b32 v4, v4, v5, vcc
  v_cmp_le_u32 vcc, 21, v3
  s_nop 1
  v_cndmask_b32 v4, v4, v6, vcc
  v_add_u32 v1, v1, v4
  v_add_u32 v1, s13, v1
  v_subrev_u32 v14, 2048, v1
  buffer_load_dwordx4 v14, s[44:47], s60 offen offset:2048 lds
  v_lshrrev_b32 v1, 5, v0
  v_add_u32 v1, 6, v1
  v_and_b32 v2, 3, v1
  v_lshlrev_b32 v2, 2, v2
  v_and_b32 v3, 31, v0
  v_xor_b32 v3, v3, v2
  v_add_u32 v1, s12, v1
  v_mul_u32_u24 v1, 3840, v1
  v_min_u32 v4, 9, v3
  v_lshlrev_b32 v4, 4, v4
  v_subrev_u32 v5, 11, v3
  v_lshlrev_b32 v5, 4, v5
  v_add_u32 v5, 1280, v5
  v_min_u32 v6, 30, v3
  v_subrev_u32 v6, 21, v6
  v_lshlrev_b32 v6, 4, v6
  v_add_u32 v6, 2560, v6
  v_cmp_le_u32 vcc, 11, v3
  s_nop 1
  v_cndmask_b32 v4, v4, v5, vcc
  v_cmp_le_u32 vcc, 21, v3
  s_nop 1
  v_cndmask_b32 v4, v4, v6, vcc
  v_add_u32 v1, v1, v4
  v_add_u32 v1, s13, v1
  v_subrev_u32 v15, 3072, v1
  buffer_load_dwordx4 v15, s[44:47], s60 offen offset:3072 lds
  s_add_u32 m0, s65, 65536
  s_mov_b32 s60, s99
  s_add_u32 s99, s99, 122880
  s_cmp_eq_u32 s99, 2457600
  s_cselect_b32 s99, 0, s99
  buffer_load_dwordx4 v12, s[44:47], s60 offen offset:0 lds
  buffer_load_dwordx4 v13, s[44:47], s60 offen offset:1024 lds
  buffer_load_dwordx4 v14, s[44:47], s60 offen offset:2048 lds
  buffer_load_dwordx4 v15, s[44:47], s60 offen offset:3072 lds
  s_add_u32 m0, s66, 16384
  s_mov_b32 s60, s69
  s_add_u32 s69, s69, 128
  s_cmp_eq_u32 s69, 1280
  s_cselect_b32 s69, 0, s69
  buffer_load_dwordx4 v8, s[40:43], s60 offen offset:0 lds
  buffer_load_dwordx4 v9, s[40:43], s60 offen offset:1024 lds
  buffer_load_dwordx4 v10, s[40:43], s60 offen offset:2048 lds
  buffer_load_dwordx4 v11, s[40:43], s60 offen offset:3072 lds
  s_add_u32 m0, s65, 81920
  s_mov_b32 s60, s99
  s_add_u32 s99, s99, 122880
  s_cmp_eq_u32 s99, 2457600
  s_cselect_b32 s99, 0, s99
  buffer_load_dwordx4 v12, s[44:47], s60 offen offset:0 lds
  buffer_load_dwordx4 v13, s[44:47], s60 offen offset:1024 lds
  buffer_load_dwordx4 v14, s[44:47], s60 offen offset:2048 lds
  buffer_load_dwordx4 v15, s[44:47], s60 offen offset:3072 lds
  s_add_u32 m0, s65, 98304
  s_mov_b32 s60, s99
  s_add_u32 s99, s99, 122880
  s_cmp_eq_u32 s99, 2457600
  s_cselect_b32 s99, 0, s99
  buffer_load_dwordx4 v12, s[44:47], s60 offen offset:0 lds
  buffer_load_dwordx4 v13, s[44:47], s60 offen offset:1024 lds
  buffer_load_dwordx4 v14, s[44:47], s60 offen offset:2048 lds
  buffer_load_dwordx4 v15, s[44:47], s60 offen offset:3072 lds
  s_waitcnt vmcnt(16)
  s_barrier
  s_add_u32 m0, s66, 32768
  s_mov_b32 s60, s69
  s_add_u32 s69, s69, 128
  s_cmp_eq_u32 s69, 1280
  s_cselect_b32 s69, 0, s69
  buffer_load_dwordx4 v8, s[40:43], s60 offen offset:0 lds
  buffer_load_dwordx4 v9, s[40:43], s60 offen offset:1024 lds
  buffer_load_dwordx4 v10, s[40:43], s60 offen offset:2048 lds
  buffer_load_dwordx4 v11, s[40:43], s60 offen offset:3072 lds
  s_add_u32 m0, s65, 114688
  s_mov_b32 s60, s99
  s_add_u32 s99, s99, 122880
  s_cmp_eq_u32 s99, 2457600
  s_cselect_b32 s99, 0, s99
  buffer_load_dwordx4 v12, s[44:47], s60 offen offset:0 lds
  buffer_load_dwordx4 v13, s[44:47], s60 offen offset:1024 lds
  buffer_load_dwordx4 v14, s[44:47], s60 offen offset:2048 lds
  buffer_load_dwordx4 v15, s[44:47], s60 offen offset:3072 lds
  s_add_u32 m0, s65, 131072
  s_mov_b32 s60, s99
  s_add_u32 s99, s99, 122880
  s_cmp_eq_u32 s99, 2457600
  s_cselect_b32 s99, 0, s99
  buffer_load_dwordx4 v12, s[44:47], s60 offen offset:0 lds
  buffer_load_dwordx4 v13, s[44:47], s60 offen offset:1024 lds
  buffer_load_dwordx4 v14, s[44:47], s60 offen offset:2048 lds
  buffer_load_dwordx4 v15, s[44:47], s60 offen offset:3072 lds
  v_mov_b32 v25, 0
  global_load_dword v24, v25, s[34:35] sc1
  v_and_b32 v1, 15, v0
  s_lshl_b32 s13, s8, 4
  v_add_u32 v3, s13, v1
  v_add_u32 v3, 128, v3
  s_lshl_b32 s13, s4, 3
  v_and_b32 v4, 7, v1
  v_add_u32 v4, s13, v4
  v_min_u32 v5, 11, v1
  v_lshrrev_b32 v6, 1, v5
  v_and_b32 v5, 1, v5
  s_mul_i32 s13, s5, 80
  s_lshr_b32 s13, s13, 6
  v_lshrrev_b32 v7, 1, v6
  v_mul_u32_u24 v7, 10, v7
  v_and_b32 v2, 1, v6
  v_add_u32 v7, v7, v2
  v_add_u32 v7, s13, v7
  v_lshl_add_u32 v7, v7, 1, v5
  v_and_b32 v7, 127, v7
  v_add_u32 v4, 256, v4
  s_nop 0
  v_lshlrev_b32 v3, 7, v3
  v_add_u32 v22, 49152, v3
  s_cmp_lt_u32 s61, 2
  s_cselect_b64 vcc, -1, 0
  v_cndmask_b32 v4, v4, v7, vcc
  v_lshlrev_b32 v4, 7, v4
  v_add_u32 v27, 49152, v4
  s_mov_b32 s48, s36
  s_mov_b32 s49, s37
  s_mov_b32 s50, 2097152
  s_mov_b32 s51, 0x20000
  v_lshrrev_b32 v2, 4, v0
  v_bfe_u32 v4, v0, 3, 1
  v_and_b32 v5, 7, v0
  s_lshl_b32 s13, s5, 2
  v_add_u32 v2, s13, v2
  v_mul_u32_u24 v2, 20, v2
  v_lshlrev_b32 v6, 2, v5
  v_min_u32 v7, 6, v5
  v_lshlrev_b32 v7, 2, v7
  v_add_u32 v7, 1272, v7
  v_cmp_gt_u32 vcc, 5, v5
  s_nop 1
  v_cndmask_b32 v7, v7, v6, vcc
  v_add_u32 v3, 640, v6
  v_add_u32 v1, 1260, v6
  v_cndmask_b32 v3, v1, v3, vcc
  v_cmp_eq_u32 vcc, 1, v4
  s_nop 1
  v_cndmask_b32 v6, v7, v3, vcc
  v_add_u32 v6, v6, v2
  v_lshlrev_b32 v6, 2, v6
  v_add_u32 v36, 999424, v6
  v_add_u32 v37, 1019392, v6
  v_lshlrev_b32 v1, 4, v0
  v_add_u32 v38, 148736, v1
  s_cmp_lt_u32 s61, 2
  s_cbranch_scc1 L_gs_16
  s_lshl_b32 s13, s4, 10
  s_add_u32 s13, s13, 98304
  v_lshl_add_u32 v36, v0, 4, s13
  v_mov_b32 v37, v36
  v_lshlrev_b32 v1, 4, v0
  v_add_u32 v38, 147712, v1
L_gs_16:
  s_add_u32 s92, s36, 2097152
  s_addc_u32 s93, s37, 0
  s_mov_b32 s94, 2785280
  s_mov_b32 s95, 0x20000
  v_lshlrev_b32 v40, 4, v0
  s_mul_i32 s12, s8, 348160
  s_mul_i32 s13, s61, 61440
  s_add_u32 s86, s12, s13
  s_mul_i32 s13, s61, 25600
  s_add_u32 s87, s12, s13
  s_add_u32 s87, s87, 245760
  s_mul_i32 s88, s61, 10240
  v_add_u32 v41, s88, v40
  s_waitcnt vmcnt(25)
  s_barrier
  s_add_u32 m0, s65, 49152
  s_mov_b32 s60, s99
  s_add_u32 s99, s99, 122880
  s_cmp_eq_u32 s99, 2457600
  s_cselect_b32 s99, 0, s99
  buffer_load_dwordx4 v12, s[44:47], s60 offen offset:0 lds
  buffer_load_dwordx4 v13, s[44:47], s60 offen offset:1024 lds
  buffer_load_dwordx4 v14, s[44:47], s60 offen offset:2048 lds
  buffer_load_dwordx4 v15, s[44:47], s60 offen offset:3072 lds
  s_waitcnt vmcnt(21)
  s_barrier
  s_add_u32 m0, s66, 0
  s_mov_b32 s60, s69
  s_add_u32 s69, s69, 128
  s_cmp_eq_u32 s69, 1280
  s_cselect_b32 s69, 0, s69
  buffer_load_dwordx4 v8, s[40:43], s60 offen offset:0 lds
  buffer_load_dwordx4 v9, s[40:43], s60 offen offset:1024 lds
  buffer_load_dwordx4 v10, s[40:43], s60 offen offset:2048 lds
  buffer_load_dwordx4 v11, s[40:43], s60 offen offset:3072 lds
  s_add_u32 m0, s65, 65536
  s_mov_b32 s60, s99
  s_add_u32 s99, s99, 122880
  s_cmp_eq_u32 s99, 2457600
  s_cselect_b32 s99, 0, s99
  buffer_load_dwordx4 v12, s[44:47], s60 offen offset:0 lds
  buffer_load_dwordx4 v13, s[44:47], s60 offen offset:1024 lds
  buffer_load_dwordx4 v14, s[44:47], s60 offen offset:2048 lds
  buffer_load_dwordx4 v15, s[44:47], s60 offen offset:3072 lds
  s_waitcnt vmcnt(25)
  s_barrier
  s_add_u32 m0, s65, 81920
  s_mov_b32 s60, s99
  s_add_u32 s99, s99, 122880
  s_cmp_eq_u32 s99, 2457600
  s_cselect_b32 s99, 0, s99
  buffer_load_dwordx4 v12, s[44:47], s60 offen offset:0 lds
  buffer_load_dwordx4 v13, s[44:47], s60 offen offset:1024 lds
  buffer_load_dwordx4 v14, s[44:47], s60 offen offset:2048 lds
  buffer_load_dwordx4 v15, s[44:47], s60 offen offset:3072 lds
  s_waitcnt vmcnt(21)
  s_barrier
  s_add_u32 m0, s66, 16384
  s_mov_b32 s60, s69
  s_add_u32 s69, s69, 128
  s_cmp_eq_u32 s69, 1280
  s_cselect_b32 s69, 0, s69
  buffer_load_dwordx4 v8, s[40:43], s60 offen offset:0 lds
  buffer_load_dwordx4 v9, s[40:43], s60 offen offset:1024 lds
  buffer_load_dwordx4 v10, s[40:43], s60 offen offset:2048 lds
  buffer_load_dwordx4 v11, s[40:43], s60 offen offset:3072 lds
  s_add_u32 m0, s65, 98304
  s_mov_b32 s60, s99
  s_add_u32 s99, s99, 122880
  s_cmp_eq_u32 s99, 2457600
  s_cselect_b32 s99, 0, s99
  buffer_load_dwordx4 v12, s[44:47], s60 offen offset:0 lds
  buffer_load_dwordx4 v13, s[44:47], s60 offen offset:1024 lds
  buffer_load_dwordx4 v14, s[44:47], s60 offen offset:2048 lds
  buffer_load_dwordx4 v15, s[44:47], s60 offen offset:3072 lds
  s_waitcnt vmcnt(25)
  s_barrier
  s_add_u32 m0, s65, 114688
  s_mov_b32 s60, s99
  s_add_u32 s99, s99, 122880
  s_cmp_eq_u32 s99, 2457600
  s_cselect_b32 s99, 0, s99
  buffer_load_dwordx4 v12, s[44:47], s60 offen offset:0 lds
  buffer_load_dwordx4 v13, s[44:47], s60 offen offset:1024 lds
  buffer_load_dwordx4 v14, s[44:47], s60 offen offset:2048 lds
  buffer_load_dwordx4 v15, s[44:47], s60 offen offset:3072 lds
  s_waitcnt vmcnt(20)
  s_barrier
  s_add_u32 m0, s66, 32768
  s_mov_b32 s60, s69
  s_add_u32 s69, s69, 128
  s_cmp_eq_u32 s69, 1280
  s_cselect_b32 s69, 0, s69
  buffer_load_dwordx4 v8, s[40:43], s60 offen offset:0 lds
  buffer_load_dwordx4 v9, s[40:43], s60 offen offset:1024 lds
  buffer_load_dwordx4 v10, s[40:43], s60 offen offset:2048 lds
  buffer_load_dwordx4 v11, s[40:43], s60 offen offset:3072 lds
  s_add_u32 m0, s65, 131072
  s_mov_b32 s60, s99
  s_add_u32 s99, s99, 122880
  s_cmp_eq_u32 s99, 2457600
  s_cselect_b32 s99, 0, s99
  buffer_load_dwordx4 v12, s[44:47], s60 offen offset:0 lds
  buffer_load_dwordx4 v13, s[44:47], s60 offen offset:1024 lds
  buffer_load_dwordx4 v14, s[44:47], s60 offen offset:2048 lds
  buffer_load_dwordx4 v15, s[44:47], s60 offen offset:3072 lds
  s_waitcnt vmcnt(24)
  s_barrier
  s_add_u32 m0, s65, 49152
  s_mov_b32 s60, s99
  s_add_u32 s99, s99, 122880
  s_cmp_eq_u32 s99, 2457600
  s_cselect_b32 s99, 0, s99
  buffer_load_dwordx4 v12, s[44:47], s60 offen offset:0 lds
  buffer_load_dwordx4 v13, s[44:47], s60 offen offset:1024 lds
  buffer_load_dwordx4 v14, s[44:47], s60 offen offset:2048 lds
  buffer_load_dwordx4 v15, s[44:47], s60 offen offset:3072 lds
  s_waitcnt vmcnt(20)
  s_barrier
  s_add_u32 m0, s66, 0
  s_mov_b32 s60, s69
  s_add_u32 s69, s69, 128
  s_cmp_eq_u32 s69, 1280
  s_cselect_b32 s69, 0, s69
  buffer_load_dwordx4 v8, s[40:43], s60 offen offset:0 lds
  buffer_load_dwordx4 v9, s[40:43], s60 offen offset:1024 lds
  buffer_load_dwordx4 v10, s[40:43], s60 offen offset:2048 lds
  buffer_load_dwordx4 v11, s[40:43], s60 offen offset:3072 lds
  s_add_u32 m0, s65, 65536
  s_mov_b32 s60, s99
  s_add_u32 s99, s99, 122880
  s_cmp_eq_u32 s99, 2457600
  s_cselect_b32 s99, 0, s99
  buffer_load_dwordx4 v12, s[44:47], s60 offen offset:0 lds
  buffer_load_dwordx4 v13, s[44:47], s60 offen offset:1024 lds
  buffer_load_dwordx4 v14, s[44:47], s60 offen offset:2048 lds
  buffer_load_dwordx4 v15, s[44:47], s60 offen offset:3072 lds
  s_waitcnt vmcnt(24)
  s_barrier
  s_add_u32 m0, s65, 81920
  s_mov_b32 s60, s99
  s_add_u32 s99, s99, 122880
  s_cmp_eq_u32 s99, 2457600
  s_cselect_b32 s99, 0, s99
  buffer_load_dwordx4 v12, s[44:47], s60 offen offset:0 lds
  buffer_load_dwordx4 v13, s[44:47], s60 offen offset:1024 lds
  buffer_load_dwordx4 v14, s[44:47], s60 offen offset:2048 lds
  buffer_load_dwordx4 v15, s[44:47], s60 offen offset:3072 lds
  s_waitcnt vmcnt(20)
  s_barrier
  s_add_u32 m0, s66, 16384
  s_mov_b32 s60, s69
  s_add_u32 s69, s69, 128
  s_cmp_eq_u32 s69, 1280
  s_cselect_b32 s69, 0, s69
  buffer_load_dwordx4 v8, s[40:43], s60 offen offset:0 lds
  buffer_load_dwordx4 v9, s[40:43], s60 offen offset:1024 lds
  buffer_load_dwordx4 v10, s[40:43], s60 offen offset:2048 lds
  buffer_load_dwordx4 v11, s[40:43], s60 offen offset:3072 lds
  s_add_u32 m0, s65, 98304
  s_mov_b32 s60, s99
  s_add_u32 s99, s99, 122880
  s_cmp_eq_u32 s99, 2457600
  s_cselect_b32 s99, 0, s99
  buffer_load_dwordx4 v12, s[44:47], s60 offen offset:0 lds
  buffer_load_dwordx4 v13, s[44:47], s60 offen offset:1024 lds
  buffer_load_dwordx4 v14, s[44:47], s60 offen offset:2048 lds
  buffer_load_dwordx4 v15, s[44:47], s60 offen offset:3072 lds
  s_waitcnt vmcnt(24)
  s_barrier
  s_add_u32 m0, s65, 114688
  s_mov_b32 s60, s99
  s_add_u32 s99, s99, 122880
  s_cmp_eq_u32 s99, 2457600
  s_cselect_b32 s99, 0, s99
  buffer_load_dwordx4 v12, s[44:47], s60 offen offset:0 lds
  buffer_load_dwordx4 v13, s[44:47], s60 offen offset:1024 lds
  buffer_load_dwordx4 v14, s[44:47], s60 offen offset:2048 lds
  buffer_load_dwordx4 v15, s[44:47], s60 offen offset:3072 lds
  s_waitcnt vmcnt(20)
  s_barrier
  s_add_u32 m0, s66, 32768
  s_mov_b32 s60, s69
  s_add_u32 s69, s69, 128
  s_cmp_eq_u32 s69, 1280
  s_cselect_b32 s69, 0, s69
  buffer_load_dwordx4 v8, s[40:43], s60 offen offset:0 lds
  buffer_load_dwordx4 v9, s[40:43], s60 offen offset:1024 lds
  buffer_load_dwordx4 v10, s[40:43], s60 offen offset:2048 lds
  buffer_load_dwordx4 v11, s[40:43], s60 offen offset:3072 lds
  s_add_u32 m0, s65, 131072
  s_mov_b32 s60, s99
  s_add_u32 s99, s99, 122880
  s_cmp_eq_u32 s99, 2457600
  s_cselect_b32 s99, 0, s99
  buffer_load_dwordx4 v12, s[44:47], s60 offen offset:0 lds
  buffer_load_dwordx4 v13, s[44:47], s60 offen offset:1024 lds
  buffer_load_dwordx4 v14, s[44:47], s60 offen offset:2048 lds
  buffer_load_dwordx4 v15, s[44:47], s60 offen offset:3072 lds
  s_waitcnt vmcnt(24)
  s_barrier
  s_add_u32 m0, s65, 49152
  s_mov_b32 s60, s99
  s_add_u32 s99, s99, 122880
  s_cmp_eq_u32 s99, 2457600
  s_cselect_b32 s99, 0, s99
  buffer_load_dwordx4 v12, s[44:47], s60 offen offset:0 lds
  buffer_load_dwordx4 v13, s[44:47], s60 offen offset:1024 lds
  buffer_load_dwordx4 v14, s[44:47], s60 offen offset:2048 lds
  buffer_load_dwordx4 v15, s[44:47], s60 offen offset:3072 lds
  s_waitcnt vmcnt(20)
  s_barrier
  s_add_u32 m0, s66, 0
  s_mov_b32 s60, s69
  s_add_u32 s69, s69, 128
  s_cmp_eq_u32 s69, 1280
  s_cselect_b32 s69, 0, s69
  buffer_load_dwordx4 v8, s[40:43], s60 offen offset:0 lds
  buffer_load_dwordx4 v9, s[40:43], s60 offen offset:1024 lds
  buffer_load_dwordx4 v10, s[40:43], s60 offen offset:2048 lds
  buffer_load_dwordx4 v11, s[40:43], s60 offen offset:3072 lds
  s_add_u32 m0, s65, 65536
  s_mov_b32 s60, s99
  s_add_u32 s99, s99, 122880
  s_cmp_eq_u32 s99, 2457600
  s_cselect_b32 s99, 0, s99
  buffer_load_dwordx4 v12, s[44:47], s60 offen offset:0 lds
  buffer_load_dwordx4 v13, s[44:47], s60 offen offset:1024 lds
  buffer_load_dwordx4 v14, s[44:47], s60 offen offset:2048 lds
  buffer_load_dwordx4 v15, s[44:47], s60 offen offset:3072 lds
  s_waitcnt vmcnt(24)
  s_barrier
  global_load_dword v26, v27, s[36:37] sc1
  s_waitcnt vmcnt(17)
  s_barrier
  s_waitcnt vmcnt(13)
  s_waitcnt vmcnt(0)
  s_barrier
  v_readfirstlane_b32 s11, v24
  s_nop 0
  s_cmp_eq_u32 s11, 0
  s_cbranch_scc1 L_fok_17_slow
  v_cmp_ne_u32 vcc, s11, v26
  s_cbranch_vccz L_fok_17
L_fok_17_slow:
  v_mov_b32 v2, 0
  s_mov_b32 s64, 0
L_tag_18:
  global_load_dword v1, v2, s[34:35] sc1
  s_waitcnt vmcnt(0)
  v_readfirstlane_b32 s11, v1
  s_add_u32 s64, s64, 1
  s_cmp_gt_u32 s64, 200000
  s_cbranch_scc1 L_tagd_19
  s_cmp_eq_u32 s11, 0
  s_cbranch_scc0 L_tagd_19
  s_sleep 1
  s_branch L_tag_18
L_tagd_19:
  v_mov_b32 v24, s11
  s_mov_b32 s64, 0
L_poll_20:
  global_load_dword v1, v27, s[36:37] sc1
  s_waitcnt vmcnt(0)
  v_cmp_ne_u32 vcc, s11, v1
  s_add_u32 s64, s64, 1
  s_cmp_gt_u32 s64, 200000
  s_cbranch_scc1 L_polld_21
  s_cbranch_vccz L_polld_21
  s_sleep 1
  s_branch L_poll_20
L_polld_21:
L_fok_17:
  buffer_load_dwordx4 v[28:31], v36, s[48:51], 0 offen sc1
  buffer_load_dwordx4 v[32:35], v37, s[48:51], 0 offen sc1
  s_barrier
  global_load_dword v23, v22, s[36:37] sc1
  s_barrier
  s_waitcnt vmcnt(1)
  s_cmp_ge_u32 s61, 2
  s_cbranch_scc1 L_gf_22
  v_add_f32 v28, v28, v32
  v_add_f32 v29, v29, v33
  v_add_f32 v30, v30, v34
  v_add_f32 v31, v31, v35
L_gf_22:
  ds_write_b128 v38, v[28:31]
  s_waitcnt lgkmcnt(0)
  s_barrier
  s_waitcnt vmcnt(0)
  v_readfirstlane_b32 s11, v24
  s_nop 0
  s_cmp_eq_u32 s11, 0
  s_cbranch_scc1 L_w2late_23
  v_cmp_ne_u32 vcc, s11, v23
  s_cbranch_vccnz L_w2late_23
  s_lshr_b32 s12, s2, 3
  s_and_b32 s12, s12, 7
  s_mul_i32 s13, s12, 7680
  s_add_u32 s13, s13, s86
  v_min_u32 v1, 59, v0
  v_lshlrev_b32 v1, 7, v1
  buffer_load_dword v42, v1, s[92:95], s13 offen sc1
  s_mul_i32 s13, s12, 3200
  s_add_u32 s13, s13, s87
  v_min_u32 v1, 24, v0
  v_lshlrev_b32 v1, 7, v1
  buffer_load_dword v43, v1, s[92:95], s13 offen sc1
  s_add_u32 m0, s88, 0
  s_add_u32 s60, s86, 0
  buffer_load_dwordx4 v40, s[92:95], s60 offen offset:0 sc1 lds
  buffer_load_dwordx4 v40, s[92:95], s60 offen offset:1024 sc1 lds
  buffer_load_dwordx4 v40, s[92:95], s60 offen offset:2048 sc1 lds
  buffer_load_dwordx4 v40, s[92:95], s60 offen offset:3072 sc1 lds
  s_add_u32 m0, s88, 4096
  s_add_u32 s60, s86, 4096
  buffer_load_dwordx4 v40, s[92:95], s60 offen offset:0 sc1 lds
  buffer_load_dwordx4 v40, s[92:95], s60 offen offset:1024 sc1 lds
  buffer_load_dwordx4 v40, s[92:95], s60 offen offset:2048 sc1 lds
  buffer_load_dwordx4 v40, s[92:95], s60 offen offset:3072 sc1 lds
  s_add_u32 m0, s88, 8192
  s_add_u32 s60, s86, 8192
  buffer_load_dwordx4 v40, s[92:95], s60 offen offset:0 sc1 lds
  buffer_load_dwordx4 v40, s[92:95], s60 offen offset:1024 sc1 lds
  s_add_u32 m0, s88, 40960
  s_add_u32 s60, s86, 10240
  buffer_load_dwordx4 v40, s[92:95], s60 offen offset:0 sc1 lds
  buffer_load_dwordx4 v40, s[92:95], s60 offen offset:1024 sc1 lds
  buffer_load_dwordx4 v40, s[92:95], s60 offen offset:2048 sc1 lds
  buffer_load_dwordx4 v40, s[92:95], s60 offen offset:3072 sc1 lds
  s_add_u32 m0, s88, 45056
  s_add_u32 s60, s86, 14336
  buffer_load_dwordx4 v40, s[92:95], s60 offen offset:0 sc1 lds
  buffer_load_dwordx4 v40, s[92:95], s60 offen offset:1024 sc1 lds
  buffer_load_dwordx4 v40, s[92:95], s60 offen offset:2048 sc1 lds
  buffer_load_dwordx4 v40, s[92:95], s60 offen offset:3072 sc1 lds
  s_add_u32 m0, s88, 49152
  s_add_u32 s60, s86, 18432
  buffer_load_dwordx4 v40, s[92:95], s60 offen offset:0 sc1 lds
  buffer_load_dwordx4 v40, s[92:95], s60 offen offset:1024 sc1 lds
  s_add_u32 s60, s86, 30720
  buffer_load_dwordx4 v[44:47], v40, s[92:95], s60 offen sc1
  s_add_u32 s60, s86, 31744
  buffer_load_dwordx4 v[48:51], v40, s[92:95], s60 offen sc1
  s_add_u32 s60, s86, 32768
  buffer_load_dwordx4 v[52:55], v40, s[92:95], s60 offen sc1
  s_add_u32 s60, s86, 33792
  buffer_load_dwordx4 v[56:59], v40, s[92:95], s60 offen sc1
  s_add_u32 s60, s86, 34816
  buffer_load_dwordx4 v[60:63], v40, s[92:95], s60 offen sc1
  s_add_u32 s60, s86, 35840
  buffer_load_dwordx4 v[64:67], v40, s[92:95], s60 offen sc1
  s_add_u32 s60, s86, 36864
  buffer_load_dwordx4 v[68:71], v40, s[92:95], s60 offen sc1
  s_add_u32 s60, s86, 37888
  buffer_load_dwordx4 v[72:75], v40, s[92:95], s60 offen sc1
  s_add_u32 s60, s86, 38912
  buffer_load_dwordx4 v[76:79], v40, s[92:95], s60 offen sc1
  s_add_u32 s60, s86, 39936
  buffer_load_dwordx4 v[80:83], v40, s[92:95], s60 offen sc1
  s_add_u32 s60, s86, 40960
  buffer_load_dwordx4 v[84:87], v40, s[92:95], s60 offen sc1
  s_add_u32 s60, s86, 41984
  buffer_load_dwordx4 v[88:91], v40, s[92:95], s60 offen sc1
  s_add_u32 s60, s86, 43008
  buffer_load_dwordx4 v[92:95], v40, s[92:95], s60 offen sc1
  s_add_u32 s60, s86, 44032
  buffer_load_dwordx4 v[96:99], v40, s[92:95], s60 offen sc1
  s_add_u32 s60, s86, 45056
  buffer_load_dwordx4 v[100:103], v40, s[92:95], s60 offen sc1
  s_add_u32 s60, s86, 46080
  buffer_load_dwordx4 v[104:107], v40, s[92:95], s60 offen sc1
  s_add_u32 s60, s86, 47104
  buffer_load_dwordx4 v[108:111], v40, s[92:95], s60 offen sc1
  s_add_u32 s60, s86, 48128
  buffer_load_dwordx4 v[112:115], v40, s[92:95], s60 offen sc1
  s_add_u32 s60, s86, 49152
  buffer_load_dwordx4 v[116:119], v40, s[92:95], s60 offen sc1
  s_add_u32 s60, s86, 50176
  buffer_load_dwordx4 v[120:123], v40, s[92:95], s60 offen sc1
  s_add_u32 s60, s86, 51200
  buffer_load_dwordx4 v[124:127], v40, s[92:95], s60 offen sc1
  s_add_u32 s60, s86, 52224
  buffer_load_dwordx4 v[128:131], v40, s[92:95], s60 offen sc1
  s_add_u32 s60, s86, 53248
  buffer_load_dwordx4 v[132:135], v40, s[92:95], s60 offen sc1
  s_add_u32 s60, s86, 54272
  buffer_load_dwordx4 v[136:139], v40, s[92:95], s60 offen sc1
  s_add_u32 s60, s86, 55296
  buffer_load_dwordx4 v[140:143], v40, s[92:95], s60 offen sc1
  s_add_u32 s60, s86, 56320
  buffer_load_dwordx4 v[144:147], v40, s[92:95], s60 offen sc1
  s_add_u32 s60, s86, 57344
  buffer_load_dwordx4 v[148:151], v40, s[92:95], s60 offen sc1
  s_add_u32 s60, s86, 58368
  buffer_load_dwordx4 v[152:155], v40, s[92:95], s60 offen sc1
  s_add_u32 s60, s86, 59392
  buffer_load_dwordx4 v[156:159], v40, s[92:95], s60 offen sc1
  s_add_u32 s60, s86, 60416
  buffer_load_dwordx4 v[160:163], v40, s[92:95], s60 offen sc1
  s_add_u32 s60, s87, 0
  buffer_load_dwordx4 v[8:11], v40, s[92:95], s60 offen sc1
  s_add_u32 s60, s87, 1024
  buffer_load_dwordx4 v[12:15], v40, s[92:95], s60 offen sc1
  s_add_u32 s60, s87, 2048
  buffer_load_dwordx4 v[16:19], v40, s[92:95], s60 offen sc1
  s_add_u32 s60, s87, 3072
  buffer_load_dwordx4 v[20:23], v40, s[92:95], s60 offen sc1
  s_add_u32 s60, s87, 4096
  buffer_load_dwordx4 v[24:27], v40, s[92:95], s60 offen sc1
  s_add_u32 s60, s87, 5120
  buffer_load_dwordx4 v[28:31], v40, s[92:95], s60 offen sc1
  s_add_u32 s60, s87, 6144
  buffer_load_dwordx4 v[32:35], v40, s[92:95], s60 offen sc1
  s_add_u32 s60, s87, 7168
  buffer_load_dwordx4 v[36:39], v40, s[92:95], s60 offen sc1
  s_barrier
  s_barrier
  s_branch L_w2join_24
L_w2late_23:
  s_barrier
  s_barrier
  v_mov_b32 v2, 0
  s_mov_b32 s64, 0
L_tag_25:
  global_load_dword v1, v2, s[34:35] sc1
  s_waitcnt vmcnt(0)
  v_readfirstlane_b32 s11, v1
  s_add_u32 s64, s64, 1
  s_cmp_gt_u32 s64, 200000
  s_cbranch_scc1 L_tagd_26
  s_cmp_eq_u32 s11, 0
  s_cbranch_scc0 L_tagd_26
  s_sleep 1
  s_branch L_tag_25
L_tagd_26:
  v_mov_b32 v24, s11
  s_mov_b32 s64, 0
L_poll_27:
  global_load_dword v1, v22, s[36:37] sc1
  s_waitcnt vmcnt(0)
  v_cmp_ne_u32 vcc, s11, v1
  s_add_u32 s64, s64, 1
  s_cmp_gt_u32 s64, 200000
  s_cbranch_scc1 L_polld_28
  s_cbranch_vccz L_polld_28
  s_sleep 1
  s_branch L_poll_27
L_polld_28:
  s_lshr_b32 s12, s2, 3
  s_and_b32 s12, s12, 7
  s_mul_i32 s13, s12, 7680
  s_add_u32 s13, s13, s86
  v_min_u32 v1, 59, v0
  v_lshlrev_b32 v1, 7, v1
  buffer_load_dword v42, v1, s[92:95], s13 offen sc1
  s_mul_i32 s13, s12, 3200
  s_add_u32 s13, s13, s87
  v_min_u32 v1, 24, v0
  v_lshlrev_b32 v1, 7, v1
  buffer_load_dword v43, v1, s[92:95], s13 offen sc1
  s_add_u32 m0, s88, 0
  s_add_u32 s60, s86, 0
  buffer_load_dwordx4 v40, s[92:95], s60 offen offset:0 sc1 lds
  buffer_load_dwordx4 v40, s[92:95], s60 offen offset:1024 sc1 lds
  buffer_load_dwordx4 v40, s[92:95], s60 offen offset:2048 sc1 lds
  buffer_load_dwordx4 v40, s[92:95], s60 offen offset:3072 sc1 lds
  s_add_u32 m0, s88, 4096
  s_add_u32 s60, s86, 4096
  buffer_load_dwordx4 v40, s[92:95], s60 offen offset:0 sc1 lds
  buffer_load_dwordx4 v40, s[92:95], s60 offen offset:1024 sc1 lds
  buffer_load_dwordx4 v40, s[92:95], s60 offen offset:2048 sc1 lds
  buffer_load_dwordx4 v40, s[92:95], s60 offen offset:3072 sc1 lds
  s_add_u32 m0, s88, 8192
  s_add_u32 s60, s86, 8192
  buffer_load_dwordx4 v40, s[92:95], s60 offen offset:0 sc1 lds
  buffer_load_dwordx4 v40, s[92:95], s60 offen offset:1024 sc1 lds
  s_add_u32 m0, s88, 40960
  s_add_u32 s60, s86, 10240
  buffer_load_dwordx4 v40, s[92:95], s60 offen offset:0 sc1 lds
  buffer_load_dwordx4 v40, s[92:95], s60 offen offset:1024 sc1 lds
  buffer_load_dwordx4 v40, s[92:95], s60 offen offset:2048 sc1 lds
  buffer_load_dwordx4 v40, s[92:95], s60 offen offset:3072 sc1 lds
  s_add_u32 m0, s88, 45056
  s_add_u32 s60, s86, 14336
  buffer_load_dwordx4 v40, s[92:95], s60 offen offset:0 sc1 lds
  buffer_load_dwordx4 v40, s[92:95], s60 offen offset:1024 sc1 lds
  buffer_load_dwordx4 v40, s[92:95], s60 offen offset:2048 sc1 lds
  buffer_load_dwordx4 v40, s[92:95], s60 offen offset:3072 sc1 lds
  s_add_u32 m0, s88, 49152
  s_add_u32 s60, s86, 18432
  buffer_load_dwordx4 v40, s[92:95], s60 offen offset:0 sc1 lds
  buffer_load_dwordx4 v40, s[92:95], s60 offen offset:1024 sc1 lds
  s_add_u32 s60, s86, 30720
  buffer_load_dwordx4 v[44:47], v40, s[92:95], s60 offen sc1
  s_add_u32 s60, s86, 31744
  buffer_load_dwordx4 v[48:51], v40, s[92:95], s60 offen sc1
  s_add_u32 s60, s86, 32768
  buffer_load_dwordx4 v[52:55], v40, s[92:95], s60 offen sc1
  s_add_u32 s60, s86, 33792
  buffer_load_dwordx4 v[56:59], v40, s[92:95], s60 offen sc1
  s_add_u32 s60, s86, 34816
  buffer_load_dwordx4 v[60:63], v40, s[92:95], s60 offen sc1
  s_add_u32 s60, s86, 35840
  buffer_load_dwordx4 v[64:67], v40, s[92:95], s60 offen sc1
  s_add_u32 s60, s86, 36864
  buffer_load_dwordx4 v[68:71], v40, s[92:95], s60 offen sc1
  s_add_u32 s60, s86, 37888
  buffer_load_dwordx4 v[72:75], v40, s[92:95], s60 offen sc1
  s_add_u32 s60, s86, 38912
  buffer_load_dwordx4 v[76:79], v40, s[92:95], s60 offen sc1
  s_add_u32 s60, s86, 39936
  buffer_load_dwordx4 v[80:83], v40, s[92:95], s60 offen sc1
  s_add_u32 s60, s86, 40960
  buffer_load_dwordx4 v[84:87], v40, s[92:95], s60 offen sc1
  s_add_u32 s60, s86, 41984
  buffer_load_dwordx4 v[88:91], v40, s[92:95], s60 offen sc1
  s_add_u32 s60, s86, 43008
  buffer_load_dwordx4 v[92:95], v40, s[92:95], s60 offen sc1
  s_add_u32 s60, s86, 44032
  buffer_load_dwordx4 v[96:99], v40, s[92:95], s60 offen sc1
  s_add_u32 s60, s86, 45056
  buffer_load_dwordx4 v[100:103], v40, s[92:95], s60 offen sc1
  s_add_u32 s60, s86, 46080
  buffer_load_dwordx4 v[104:107], v40, s[92:95], s60 offen sc1
  s_add_u32 s60, s86, 47104
  buffer_load_dwordx4 v[108:111], v40, s[92:95], s60 offen sc1
  s_add_u32 s60, s86, 48128
  buffer_load_dwordx4 v[112:115], v40, s[92:95], s60 offen sc1
  s_add_u32 s60, s86, 49152
  buffer_load_dwordx4 v[116:119], v40, s[92:95], s60 offen sc1
  s_add_u32 s60, s86, 50176
  buffer_load_dwordx4 v[120:123], v40, s[92:95], s60 offen sc1
  s_add_u32 s60, s86, 51200
  buffer_load_dwordx4 v[124:127], v40, s[92:95], s60 offen sc1
  s_add_u32 s60, s86, 52224
  buffer_load_dwordx4 v[128:131], v40, s[92:95], s60 offen sc1
  s_add_u32 s60, s86, 53248
  buffer_load_dwordx4 v[132:135], v40, s[92:95], s60 offen sc1
  s_add_u32 s60, s86, 54272
  buffer_load_dwordx4 v[136:139], v40, s[92:95], s60 offen sc1
  s_add_u32 s60, s86, 55296
  buffer_load_dwordx4 v[140:143], v40, s[92:95], s60 offen sc1
  s_add_u32 s60, s86, 56320
  buffer_load_dwordx4 v[144:147], v40, s[92:95], s60 offen sc1
  s_add_u32 s60, s86, 57344
  buffer_load_dwordx4 v[148:151], v40, s[92:95], s60 offen sc1
  s_add_u32 s60, s86, 58368
  buffer_load_dwordx4 v[152:155], v40, s[92:95], s60 offen sc1
  s_add_u32 s60, s86, 59392
  buffer_load_dwordx4 v[156:159], v40, s[92:95], s60 offen sc1
  s_add_u32 s60, s86, 60416
  buffer_load_dwordx4 v[160:163], v40, s[92:95], s60 offen sc1
  s_add_u32 s60, s87, 0
  buffer_load_dwordx4 v[8:11], v40, s[92:95], s60 offen sc1
  s_add_u32 s60, s87, 1024
  buffer_load_dwordx4 v[12:15], v40, s[92:95], s60 offen sc1
  s_add_u32 s60, s87, 2048
  buffer_load_dwordx4 v[16:19], v40, s[92:95], s60 offen sc1
  s_add_u32 s60, s87, 3072
  buffer_load_dwordx4 v[20:23], v40, s[92:95], s60 offen sc1
  s_add_u32 s60, s87, 4096
  buffer_load_dwordx4 v[24:27], v40, s[92:95], s60 offen sc1
  s_add_u32 s60, s87, 5120
  buffer_load_dwordx4 v[28:31], v40, s[92:95], s60 offen sc1
  s_add_u32 s60, s87, 6144
  buffer_load_dwordx4 v[32:35], v40, s[92:95], s60 offen sc1
  s_add_u32 s60, s87, 7168
  buffer_load_dwordx4 v[36:39], v40, s[92:95], s60 offen sc1
L_w2join_24:
  s_waitcnt vmcnt(38)
  s_add_u32 m0, s88, 81920
  s_add_u32 s60, s86, 20480
  buffer_load_dwordx4 v40, s[92:95], s60 offen offset:0 sc1 lds
  buffer_load_dwordx4 v40, s[92:95], s60 offen offset:1024 sc1 lds
  buffer_load_dwordx4 v40, s[92:95], s60 offen offset:2048 sc1 lds
  buffer_load_dwordx4 v40, s[92:95], s60 offen offset:3072 sc1 lds
  s_add_u32 m0, s88, 86016
  s_add_u32 s60, s86, 24576
  buffer_load_dwordx4 v40, s[92:95], s60 offen offset:0 sc1 lds
  buffer_load_dwordx4 v40, s[92:95], s60 offen offset:1024 sc1 lds
  buffer_load_dwordx4 v40, s[92:95], s60 offen offset:2048 sc1 lds
  buffer_load_dwordx4 v40, s[92:95], s60 offen offset:3072 sc1 lds
  s_add_u32 m0, s88, 90112
  s_add_u32 s60, s86, 28672
  buffer_load_dwordx4 v40, s[92:95], s60 offen offset:0 sc1 lds
  buffer_load_dwordx4 v40, s[92:95], s60 offen offset:1024 sc1 lds
  s_barrier
  s_barrier
  s_barrier
  s_waitcnt vmcnt(18)
  v_add_u32 v42, 122880, v41
  ds_write_b128 v42, v[44:47] offset:0
  ds_write_b128 v42, v[48:51] offset:1024
  ds_write_b128 v42, v[52:55] offset:2048
  ds_write_b128 v42, v[56:59] offset:3072
  ds_write_b128 v42, v[60:63] offset:4096
  ds_write_b128 v42, v[64:67] offset:5120
  ds_write_b128 v42, v[68:71] offset:6144
  ds_write_b128 v42, v[72:75] offset:7168
  ds_write_b128 v42, v[76:79] offset:8192
  ds_write_b128 v42, v[80:83] offset:9216
  s_waitcnt vmcnt(0)
  s_waitcnt lgkmcnt(0)
  s_barrier
  v_add_u32 v42, 0, v41
  ds_write_b128 v42, v[84:87] offset:0
  ds_write_b128 v42, v[88:91] offset:1024
  ds_write_b128 v42, v[92:95] offset:2048
  ds_write_b128 v42, v[96:99] offset:3072
  ds_write_b128 v42, v[100:103] offset:4096
  ds_write_b128 v42, v[104:107] offset:5120
  ds_write_b128 v42, v[108:111] offset:6144
  ds_write_b128 v42, v[112:115] offset:7168
  ds_write_b128 v42, v[116:119] offset:8192
  ds_write_b128 v42, v[120:123] offset:9216
  v_add_u32 v42, 40960, v41
  ds_write_b128 v42, v[124:127] offset:0
  ds_write_b128 v42, v[128:131] offset:1024
  ds_write_b128 v42, v[132:135] offset:2048
  ds_write_b128 v42, v[136:139] offset:3072
  ds_write_b128 v42, v[140:143] offset:4096
  ds_write_b128 v42, v[144:147] offset:5120
  ds_write_b128 v42, v[148:151] offset:6144
  ds_write_b128 v42, v[152:155] offset:7168
  ds_write_b128 v42, v[156:159] offset:8192
  ds_write_b128 v42, v[160:163] offset:9216
  s_waitcnt lgkmcnt(0)
  s_barrier
  s_add_u32 m0, s88, 122880
  s_add_u32 s60, s87, 10240
  buffer_load_dwordx4 v40, s[92:95], s60 offen offset:0 sc1 lds
  buffer_load_dwordx4 v40, s[92:95], s60 offen offset:1024 sc1 lds
  buffer_load_dwordx4 v40, s[92:95], s60 offen offset:2048 sc1 lds
  buffer_load_dwordx4 v40, s[92:95], s60 offen offset:3072 sc1 lds
  s_add_u32 m0, s88, 126976
  s_add_u32 s60, s87, 14336
  buffer_load_dwordx4 v40, s[92:95], s60 offen offset:0 sc1 lds
  buffer_load_dwordx4 v40, s[92:95], s60 offen offset:1024 sc1 lds
  buffer_load_dwordx4 v40, s[92:95], s60 offen offset:2048 sc1 lds
  buffer_load_dwordx4 v40, s[92:95], s60 offen offset:3072 sc1 lds
  s_add_u32 m0, s88, 131072
  s_add_u32 s60, s87, 18432
  buffer_load_dwordx4 v40, s[92:95], s60 offen offset:0 sc1 lds
  buffer_load_dwordx4 v40, s[92:95], s60 offen offset:1024 sc1 lds
  s_add_u32 m0, s88, 90112
  s_add_u32 s60, s87, 8192
  buffer_load_dwordx4 v40, s[92:95], s60 offen offset:0 sc1 lds
  buffer_load_dwordx4 v40, s[92:95], s60 offen offset:1024 sc1 lds
  v_add_u32 v42, 81920, v41
  ds_write_b128 v42, v[8:11] offset:0
  ds_write_b128 v42, v[12:15] offset:1024
  ds_write_b128 v42, v[16:19] offset:2048
  ds_write_b128 v42, v[20:23] offset:3072
  ds_write_b128 v42, v[24:27] offset:4096
  ds_write_b128 v42, v[28:31] offset:5120
  ds_write_b128 v42, v[32:35] offset:6144
  ds_write_b128 v42, v[36:39] offset:7168
  s_waitcnt vmcnt(0)
  s_waitcnt lgkmcnt(0)
  s_barrier
  s_add_u32 m0, s88, 0
  s_add_u32 s60, s87, 20480
  buffer_load_dwordx4 v40, s[92:95], s60 offen offset:0 sc1 lds
  buffer_load_dwordx4 v40, s[92:95], s60 offen offset:1024 sc1 lds
  buffer_load_dwordx4 v40, s[92:95], s60 offen offset:2048 sc1 lds
  buffer_load_dwordx4 v40, s[92:95], s60 offen offset:3072 sc1 lds
  s_add_u32 m0, s88, 4096
  s_add_u32 s60, s87, 24576
  buffer_load_dwordx4 v40, s[92:95], s60 offen offset:0 sc1 lds
  s_waitcnt vmcnt(0)
  s_waitcnt lgkmcnt(0)
  s_barrier
  s_barrier
L_ld_end:
  s_endpgm
L_compute:
  s_lshr_b32 s9, s3, 2
  s_and_b32 s10, s3, 3
  s_waitcnt lgkmcnt(0)
  s_xor_b32 s12, s2, 255
  s_or_b32 s12, s12, s3
  s_cmp_eq_u32 s12, 0
  s_cbranch_scc0 L_tagpub_29
  s_memrealtime s[14:15]
  s_waitcnt lgkmcnt(0)
  s_or_b32 s14, s14, 1
  v_mov_b32 v1, 0
  v_mov_b32 v2, s14
  v_mov_b32 v3, 0
  s_mov_b64 exec, 1
  global_atomic_cmpswap v1, v[2:3], s[34:35] sc1
  s_mov_b64 exec, -1
L_tagpub_29:
  s_cmp_eq_u32 s6, 0
  s_cbranch_scc0 L_att
  s_lshl_b32 s76, s4, 3
  s_add_u32 s76, s76, s5
  s_add_u32 s76, s76, 0
  s_lshr_b32 s12, s76, 1
  s_cmp_lt_u32 s12, 30
  s_cselect_b32 s40, s18, s26
  s_cselect_b32 s41, s19, s27
  s_cselect_b32 s13, 0, 30
  s_mov_b32 s14, 3072
  s_cselect_b32 s14, 3840, s14
  s_mov_b32 s42, 1966080
  s_cselect_b32 s42, 2457600, s42
  s_mov_b32 s43, 0x20000
  s_cmp_ge_u32 s12, 54
  s_cselect_b32 s40, s28, s40
  s_cselect_b32 s41, s29, s41
  s_cselect_b32 s13, 54, s13
  s_sub_u32 s12, s12, s13
  s_lshl_b32 s12, s12, 7
  s_and_b32 s13, s76, 1
  s_mul_i32 s13, s13, 320
  s_mul_i32 s15, s3, 40
  s_add_u32 s13, s13, s15
  v_lshrrev_b32 v1, 3, v0
  v_add_u32 v1, s13, v1
  v_mul_lo_u32 v1, v1, s14
  v_and_b32 v2, 7, v0
  v_lshl_add_u32 v1, v2, 4, v1
  v_add_u32 v1, s12, v1
  s_lshl_b32 s14, s14, 3
  buffer_load_dwordx4 v[120:123], v1, s[40:43], 0 offen
  v_add_u32 v1, s14, v1
  buffer_load_dwordx4 v[124:127], v1, s[40:43], 0 offen
  v_add_u32 v1, s14, v1
  buffer_load_dwordx4 v[128:131], v1, s[40:43], 0 offen
  v_add_u32 v1, s14, v1
  buffer_load_dwordx4 v[132:135], v1, s[40:43], 0 offen
  v_add_u32 v1, s14, v1
  buffer_load_dwordx4 v[136:139], v1, s[40:43], 0 offen
L_csi_30:
  s_lshl_b32 s76, s4, 3
  s_add_u32 s76, s76, s5
  s_add_u32 s76, s76, 128
  s_cmp_ge_u32 s76, 156
  s_cbranch_scc1 L_csi_31
  s_lshr_b32 s12, s76, 1
  s_cmp_lt_u32 s12, 30
  s_cselect_b32 s40, s18, s26
  s_cselect_b32 s41, s19, s27
  s_cselect_b32 s13, 0, 30
  s_mov_b32 s14, 3072
  s_cselect_b32 s14, 3840, s14
  s_mov_b32 s42, 1966080
  s_cselect_b32 s42, 2457600, s42
  s_mov_b32 s43, 0x20000
  s_cmp_ge_u32 s12, 54
  s_cselect_b32 s40, s28, s40
  s_cselect_b32 s41, s29, s41
  s_cselect_b32 s13, 54, s13
  s_sub_u32 s12, s12, s13
  s_lshl_b32 s12, s12, 7
  s_and_b32 s13, s76, 1
  s_mul_i32 s13, s13, 320
  s_mul_i32 s15, s3, 40
  s_add_u32 s13, s13, s15
  v_lshrrev_b32 v1, 3, v0
  v_add_u32 v1, s13, v1
  v_mul_lo_u32 v1, v1, s14
  v_and_b32 v2, 7, v0
  v_lshl_add_u32 v1, v2, 4, v1
  v_add_u32 v1, s12, v1
  s_lshl_b32 s14, s14, 3
  buffer_load_dwordx4 v[28:31], v1, s[40:43], 0 offen
  v_add_u32 v1, s14, v1
  buffer_load_dwordx4 v[32:35], v1, s[40:43], 0 offen
  v_add_u32 v1, s14, v1
  buffer_load_dwordx4 v[36:39], v1, s[40:43], 0 offen
  v_add_u32 v1, s14, v1
  buffer_load_dwordx4 v[40:43], v1, s[40:43], 0 offen
  v_add_u32 v1, s14, v1
  buffer_load_dwordx4 v[44:47], v1, s[40:43], 0 offen
L_csi_31:
  v_and_b32 v1, 31, v0
  s_lshl_b32 s12, s9, 6
  v_add_u32 v1, s12, v1
  v_lshlrev_b32 v1, 7, v1
  v_bfe_u32 v2, v0, 1, 3
  v_lshrrev_b32 v3, 5, v0
  v_add_u32 v4, 0, v3
  v_xor_b32 v4, v4, v2
  v_lshl_add_u32 v144, v4, 4, v1
  v_add_u32 v4, 2, v3
  v_xor_b32 v4, v4, v2
  v_lshl_add_u32 v145, v4, 4, v1
  v_add_u32 v4, 4, v3
  v_xor_b32 v4, v4, v2
  v_lshl_add_u32 v146, v4, 4, v1
  v_add_u32 v4, 6, v3
  v_xor_b32 v4, v4, v2
  v_lshl_add_u32 v147, v4, 4, v1
  v_lshrrev_b32 v1, 5, v0
  v_bfe_u32 v2, v0, 2, 2
  v_lshl_add_u32 v1, v1, 3, v2
  v_mul_u32_u24 v1, 384, v1
  v_bfe_u32 v3, v0, 3, 1
  v_bfe_u32 v4, v0, 4, 1
  v_and_b32 v5, 3, v0
  v_xor_b32 v6, s10, v3
  v_lshlrev_b32 v6, 6, v6
  v_lshl_add_u32 v6, v4, 5, v6
  v_lshl_add_u32 v6, v5, 3, v6
  v_add_u32 v6, v6, v1
  v_add_u32 v148, 49152, v6
  s_lshr_b32 s12, s10, 1
  s_add_u32 s12, s12, 4
  s_and_b32 s13, s10, 1
  s_lshl_b32 s13, s13, 5
  v_xor_b32 v6, s12, v3
  v_lshlrev_b32 v6, 6, v6
  v_lshl_add_u32 v6, v5, 3, v6
  v_add_u32 v6, s13, v6
  v_add_u32 v6, v6, v1
  v_mul_u32_u24 v7, 12320, v4
  v_add_u32 v6, v6, v7
  v_add_u32 v149, 49152, v6
  v_mov_b32 v48, 0
  v_mov_b32 v49, 0
  v_mov_b32 v50, 0
  v_mov_b32 v51, 0
  v_mov_b32 v52, 0
  v_mov_b32 v53, 0
  v_mov_b32 v54, 0
  v_mov_b32 v55, 0
  v_mov_b32 v56, 0
  v_mov_b32 v57, 0
  v_mov_b32 v58, 0
  v_mov_b32 v59, 0
  v_mov_b32 v60, 0
  v_mov_b32 v61, 0
  v_mov_b32 v62, 0
  v_mov_b32 v63, 0
  v_mov_b32 v64, 0
  v_mov_b32 v65, 0
  v_mov_b32 v66, 0
  v_mov_b32 v67, 0
  v_mov_b32 v68, 0
  v_mov_b32 v69, 0
  v_mov_b32 v70, 0
  v_mov_b32 v71, 0
  v_mov_b32 v72, 0
  v_mov_b32 v73, 0
  v_mov_b32 v74, 0
  v_mov_b32 v75, 0
  v_mov_b32 v76, 0
  v_mov_b32 v77, 0
  v_mov_b32 v78, 0
  v_mov_b32 v79, 0
  v_mov_b32 v80, 0
  v_mov_b32 v81, 0
  v_mov_b32 v82, 0
  v_mov_b32 v83, 0
  v_mov_b32 v84, 0
  v_mov_b32 v85, 0
  v_mov_b32 v86, 0
  v_mov_b32 v87, 0
  v_mov_b32 v88, 0
  v_mov_b32 v89, 0
  v_mov_b32 v90, 0
  v_mov_b32 v91, 0
  v_mov_b32 v92, 0
  v_mov_b32 v93, 0
  v_mov_b32 v94, 0
  v_mov_b32 v95, 0
  v_mov_b32 v96, 0
  v_mov_b32 v97, 0
  v_mov_b32 v98, 0
  v_mov_b32 v99, 0
  v_mov_b32 v100, 0
  v_mov_b32 v101, 0
  v_mov_b32 v102, 0
  v_mov_b32 v103, 0
  s_waitcnt vmcnt(0)
  s_mov_b32 s67, 0x00003f80
  s_mov_b32 s68, 0x3f800000
  v_mov_b32 v12, 0
  v_mov_b32 v13, 0
  v_mov_b32 v14, 0
  v_mov_b32 v15, 0
  v_mov_b32 v16, 0
  v_mov_b32 v17, 0
  v_mov_b32 v18, 0
  v_mov_b32 v19, 0
  v_dot2c_f32_bf16 v12, s67, v120
  v_dot2c_f32_bf16 v13, s68, v120
  v_dot2c_f32_bf16 v14, s67, v121
  v_dot2c_f32_bf16 v15, s68, v121
  v_dot2c_f32_bf16 v16, s67, v122
  v_dot2c_f32_bf16 v17, s68, v122
  v_dot2c_f32_bf16 v18, s67, v123
  v_dot2c_f32_bf16 v19, s68, v123
  v_dot2c_f32_bf16 v12, s67, v124
  v_dot2c_f32_bf16 v13, s68, v124
  v_dot2c_f32_bf16 v14, s67, v125
  v_dot2c_f32_bf16 v15, s68, v125
  v_dot2c_f32_bf16 v16, s67, v126
  v_dot2c_f32_bf16 v17, s68, v126
  v_dot2c_f32_bf16 v18, s67, v127
  v_dot2c_f32_bf16 v19, s68, v127
  v_dot2c_f32_bf16 v12, s67, v128
  v_dot2c_f32_bf16 v13, s68, v128
  v_dot2c_f32_bf16 v14, s67, v129
  v_dot2c_f32_bf16 v15, s68, v129
  v_dot2c_f32_bf16 v16, s67, v130
  v_dot2c_f32_bf16 v17, s68, v130
  v_dot2c_f32_bf16 v18, s67, v131
  v_dot2c_f32_bf16 v19, s68, v131
  v_dot2c_f32_bf16 v12, s67, v132
  v_dot2c_f32_bf16 v13, s68, v132
  v_dot2c_f32_bf16 v14, s67, v133
  v_dot2c_f32_bf16 v15, s68, v133
  v_dot2c_f32_bf16 v16, s67, v134
  v_dot2c_f32_bf16 v17, s68, v134
  v_dot2c_f32_bf16 v18, s67, v135
  v_dot2c_f32_bf16 v19, s68, v135
  v_dot2c_f32_bf16 v12, s67, v136
  v_dot2c_f32_bf16 v13, s68, v136
  v_dot2c_f32_bf16 v14, s67, v137
  v_dot2c_f32_bf16 v15, s68, v137
  v_dot2c_f32_bf16 v16, s67, v138
  v_dot2c_f32_bf16 v17, s68, v138
  v_dot2c_f32_bf16 v18, s67, v139
  v_dot2c_f32_bf16 v19, s68, v139
  v_add_f32_dpp v12, v12, v12 row_ror:8 row_mask:0xf bank_mask:0xf
  v_add_f32_dpp v13, v13, v13 row_ror:8 row_mask:0xf bank_mask:0xf
  v_add_f32_dpp v14, v14, v14 row_ror:8 row_mask:0xf bank_mask:0xf
  v_add_f32_dpp v15, v15, v15 row_ror:8 row_mask:0xf bank_mask:0xf
  v_add_f32_dpp v16, v16, v16 row_ror:8 row_mask:0xf bank_mask:0xf
  v_add_f32_dpp v17, v17, v17 row_ror:8 row_mask:0xf bank_mask:0xf
  v_add_f32_dpp v18, v18, v18 row_ror:8 row_mask:0xf bank_mask:0xf
  v_add_f32_dpp v19, v19, v19 row_ror:8 row_mask:0xf bank_mask:0xf
  v_mov_b32 v20, v12
  v_mov_b32 v21, v13
  v_mov_b32 v22, v14
  v_mov_b32 v23, v15
  v_mov_b32 v24, v16
  v_mov_b32 v25, v17
  v_mov_b32 v26, v18
  v_mov_b32 v27, v19
  v_permlane16_swap_b32 v12, v20
  v_permlane16_swap_b32 v13, v21
  v_permlane16_swap_b32 v14, v22
  v_permlane16_swap_b32 v15, v23
  v_permlane16_swap_b32 v16, v24
  v_permlane16_swap_b32 v17, v25
  v_permlane16_swap_b32 v18, v26
  v_permlane16_swap_b32 v19, v27
  v_add_f32 v12, v12, v20
  v_add_f32 v13, v13, v21
  v_add_f32 v14, v14, v22
  v_add_f32 v15, v15, v23
  v_add_f32 v16, v16, v24
  v_add_f32 v17, v17, v25
  v_add_f32 v18, v18, v26
  v_add_f32 v19, v19, v27
  v_mov_b32 v20, v12
  v_mov_b32 v21, v13
  v_mov_b32 v22, v14
  v_mov_b32 v23, v15
  v_mov_b32 v24, v16
  v_mov_b32 v25, v17
  v_mov_b32 v26, v18
  v_mov_b32 v27, v19
  v_permlane32_swap_b32 v12, v20
  v_permlane32_swap_b32 v13, v21
  v_permlane32_swap_b32 v14, v22
  v_permlane32_swap_b32 v15, v23
  v_permlane32_swap_b32 v16, v24
  v_permlane32_swap_b32 v17, v25
  v_permlane32_swap_b32 v18, v26
  v_permlane32_swap_b32 v19, v27
  v_add_f32 v12, v12, v20
  v_add_f32 v13, v13, v21
  v_add_f32 v14, v14, v22
  v_add_f32 v15, v15, v23
  v_add_f32 v16, v16, v24
  v_add_f32 v17, v17, v25
  v_add_f32 v18, v18, v26
  v_add_f32 v19, v19, v27
  s_lshl_b32 s12, s3, 8
  s_add_u32 s12, s12, 151808
  v_lshl_add_u32 v10, v0, 5, s12
  s_mov_b64 exec, 0xff
  ds_write_b128 v10, v[12:15]
  ds_write_b128 v10, v[16:19] offset:16
  s_mov_b64 exec, -1
L_csf_32:
  s_lshl_b32 s76, s4, 3
  s_add_u32 s76, s76, s5
  s_cmp_ge_u32 s76, 28
  s_cbranch_scc1 L_csf_33
  v_mov_b32 v12, 0
  v_mov_b32 v13, 0
  v_mov_b32 v14, 0
  v_mov_b32 v15, 0
  v_mov_b32 v16, 0
  v_mov_b32 v17, 0
  v_mov_b32 v18, 0
  v_mov_b32 v19, 0
  v_dot2c_f32_bf16 v12, s67, v28
  v_dot2c_f32_bf16 v13, s68, v28
  v_dot2c_f32_bf16 v14, s67, v29
  v_dot2c_f32_bf16 v15, s68, v29
  v_dot2c_f32_bf16 v16, s67, v30
  v_dot2c_f32_bf16 v17, s68, v30
  v_dot2c_f32_bf16 v18, s67, v31
  v_dot2c_f32_bf16 v19, s68, v31
  v_dot2c_f32_bf16 v12, s67, v32
  v_dot2c_f32_bf16 v13, s68, v32
  v_dot2c_f32_bf16 v14, s67, v33
  v_dot2c_f32_bf16 v15, s68, v33
  v_dot2c_f32_bf16 v16, s67, v34
  v_dot2c_f32_bf16 v17, s68, v34
  v_dot2c_f32_bf16 v18, s67, v35
  v_dot2c_f32_bf16 v19, s68, v35
  v_dot2c_f32_bf16 v12, s67, v36
  v_dot2c_f32_bf16 v13, s68, v36
  v_dot2c_f32_bf16 v14, s67, v37
  v_dot2c_f32_bf16 v15, s68, v37
  v_dot2c_f32_bf16 v16, s67, v38
  v_dot2c_f32_bf16 v17, s68, v38
  v_dot2c_f32_bf16 v18, s67, v39
  v_dot2c_f32_bf16 v19, s68, v39
  v_dot2c_f32_bf16 v12, s67, v40
  v_dot2c_f32_bf16 v13, s68, v40
  v_dot2c_f32_bf16 v14, s67, v41
  v_dot2c_f32_bf16 v15, s68, v41
  v_dot2c_f32_bf16 v16, s67, v42
  v_dot2c_f32_bf16 v17, s68, v42
  v_dot2c_f32_bf16 v18, s67, v43
  v_dot2c_f32_bf16 v19, s68, v43
  v_dot2c_f32_bf16 v12, s67, v44
  v_dot2c_f32_bf16 v13, s68, v44
  v_dot2c_f32_bf16 v14, s67, v45
  v_dot2c_f32_bf16 v15, s68, v45
  v_dot2c_f32_bf16 v16, s67, v46
  v_dot2c_f32_bf16 v17, s68, v46
  v_dot2c_f32_bf16 v18, s67, v47
  v_dot2c_f32_bf16 v19, s68, v47
  v_add_f32_dpp v12, v12, v12 row_ror:8 row_mask:0xf bank_mask:0xf
  v_add_f32_dpp v13, v13, v13 row_ror:8 row_mask:0xf bank_mask:0xf
  v_add_f32_dpp v14, v14, v14 row_ror:8 row_mask:0xf bank_mask:0xf
  v_add_f32_dpp v15, v15, v15 row_ror:8 row_mask:0xf bank_mask:0xf
  v_add_f32_dpp v16, v16, v16 row_ror:8 row_mask:0xf bank_mask:0xf
  v_add_f32_dpp v17, v17, v17 row_ror:8 row_mask:0xf bank_mask:0xf
  v_add_f32_dpp v18, v18, v18 row_ror:8 row_mask:0xf bank_mask:0xf
  v_add_f32_dpp v19, v19, v19 row_ror:8 row_mask:0xf bank_mask:0xf
  v_mov_b32 v20, v12
  v_mov_b32 v21, v13
  v_mov_b32 v22, v14
  v_mov_b32 v23, v15
  v_mov_b32 v24, v16
  v_mov_b32 v25, v17
  v_mov_b32 v26, v18
  v_mov_b32 v27, v19
  v_permlane16_swap_b32 v12, v20
  v_permlane16_swap_b32 v13, v21
  v_permlane16_swap_b32 v14, v22
  v_permlane16_swap_b32 v15, v23
  v_permlane16_swap_b32 v16, v24
  v_permlane16_swap_b32 v17, v25
  v_permlane16_swap_b32 v18, v26
  v_permlane16_swap_b32 v19, v27
  v_add_f32 v12, v12, v20
  v_add_f32 v13, v13, v21
  v_add_f32 v14, v14, v22
  v_add_f32 v15, v15, v23
  v_add_f32 v16, v16, v24
  v_add_f32 v17, v17, v25
  v_add_f32 v18, v18, v26
  v_add_f32 v19, v19, v27
  v_mov_b32 v20, v12
  v_mov_b32 v21, v13
  v_mov_b32 v22, v14
  v_mov_b32 v23, v15
  v_mov_b32 v24, v16
  v_mov_b32 v25, v17
  v_mov_b32 v26, v18
  v_mov_b32 v27, v19
  v_permlane32_swap_b32 v12, v20
  v_permlane32_swap_b32 v13, v21
  v_permlane32_swap_b32 v14, v22
  v_permlane32_swap_b32 v15, v23
  v_permlane32_swap_b32 v16, v24
  v_permlane32_swap_b32 v17, v25
  v_permlane32_swap_b32 v18, v26
  v_permlane32_swap_b32 v19, v27
  v_add_f32 v12, v12, v20
  v_add_f32 v13, v13, v21
  v_add_f32 v14, v14, v22
  v_add_f32 v15, v15, v23
  v_add_f32 v16, v16, v24
  v_add_f32 v17, v17, v25
  v_add_f32 v18, v18, v26
  v_add_f32 v19, v19, v27
  s_lshl_b32 s12, s3, 8
  s_add_u32 s12, s12, 153856
  v_lshl_add_u32 v10, v0, 5, s12
  s_mov_b64 exec, 0xff
  ds_write_b128 v10, v[12:15]
  ds_write_b128 v10, v[16:19] offset:16
  s_mov_b64 exec, -1
L_csf_33:
  v_mov_b32 v8, 0
  v_mov_b32 v9, 0
  v_mov_b32 v10, 0
  v_mov_b32 v11, 0
  v_mov_b32 v12, 0
  v_mov_b32 v13, 0
  v_mov_b32 v14, 0
  v_mov_b32 v15, 0
  v_mov_b32 v16, 0
  v_mov_b32 v17, 0
  v_mov_b32 v18, 0
  v_mov_b32 v19, 0
  v_mov_b32 v20, 0
  v_mov_b32 v21, 0
  v_mov_b32 v22, 0
  v_mov_b32 v23, 0
  v_mov_b32 v24, 0
  v_mov_b32 v25, 0
  v_mov_b32 v26, 0
  v_mov_b32 v27, 0
  v_mov_b32 v28, 0
  v_mov_b32 v29, 0
  v_mov_b32 v30, 0
  v_mov_b32 v31, 0
  v_mov_b32 v32, 0
  v_mov_b32 v33, 0
  v_mov_b32 v34, 0
  v_mov_b32 v35, 0
  v_mov_b32 v36, 0
  v_mov_b32 v37, 0
  v_mov_b32 v38, 0
  v_mov_b32 v39, 0
  v_mov_b32 v40, 0
  v_mov_b32 v41, 0
  v_mov_b32 v42, 0
  v_mov_b32 v43, 0
  v_mov_b32 v44, 0
  v_mov_b32 v45, 0
  v_mov_b32 v46, 0
  v_mov_b32 v47, 0
  s_waitcnt lgkmcnt(0)
  s_mov_b32 s56, 0
  s_mov_b32 s57, 0
  s_mov_b32 s58, 0
  s_mov_b32 s80, 24640
  s_mov_b32 s81, 16384
  s_barrier
  v_mov_b32 v1, 0
  global_load_dword v166, v1, s[34:35] sc1
  s_cmp_lt_u32 s3, 6
  s_cbranch_scc1 L_csp_34
  s_sub_u32 s15, 7, s3
  s_lshl_b32 s76, s4, 3
  s_add_u32 s76, s76, s5
  s_lshl_b32 s12, s15, 7
  s_add_u32 s76, s76, s12
  s_cmp_ge_u32 s76, 156
  s_cbranch_scc1 L_csp_34
  s_lshl_b32 s15, s15, 11
  s_add_u32 s15, s15, 151808
  v_lshl_add_u32 v1, v0, 2, s15
  ds_read_b32 v136, v1 offset:0
  ds_read_b32 v137, v1 offset:256
  ds_read_b32 v138, v1 offset:512
  ds_read_b32 v139, v1 offset:768
  ds_read_b32 v140, v1 offset:1024
  ds_read_b32 v141, v1 offset:1280
  ds_read_b32 v142, v1 offset:1536
  ds_read_b32 v143, v1 offset:1792
  s_lshr_b32 s12, s76, 1
  s_lshl_b32 s12, s12, 8
  s_and_b32 s13, s76, 1
  s_mul_i32 s13, s13, 19968
  s_add_u32 s12, s12, s13
  s_add_u32 s12, s12, 999424
  v_lshl_add_u32 v2, v0, 2, s12
  s_waitcnt lgkmcnt(0)
  v_add_f32 v136, v136, v137
  v_add_f32 v138, v138, v139
  v_add_f32 v140, v140, v141
  v_add_f32 v142, v142, v143
  v_add_f32 v136, v136, v138
  v_add_f32 v140, v140, v142
  v_add_f32 v136, v136, v140
  global_store_dword v2, v136, s[36:37] sc1
L_csp_34:
  ds_read_b128 v[104:107], v144
  ds_read_b128 v[108:111], v144 offset:4096
  ds_read_b64_tr_b16 v[112:113], v148 offset:0
  ds_read_b64_tr_b16 v[114:115], v148 offset:1536
  ds_read_b64_tr_b16 v[116:117], v148 offset:12320
  ds_read_b64_tr_b16 v[118:119], v148 offset:13856
  ds_read_b64_tr_b16 v[120:121], v149 offset:0
  ds_read_b64_tr_b16 v[122:123], v149 offset:1536
L_main_35:
  s_waitcnt lgkmcnt(0)
  v_mfma_f32_32x32x16_bf16 v[8:23], v[112:115], v[104:107], v[8:23]
  ds_read_b128 v[124:127], v145
  ds_read_b128 v[128:131], v145 offset:4096
  ds_read_b64_tr_b16 v[132:133], v148 offset:6144
  v_mfma_f32_32x32x16_bf16 v[56:71], v[112:115], v[108:111], v[56:71]
  ds_read_b64_tr_b16 v[134:135], v148 offset:7680
  ds_read_b64_tr_b16 v[136:137], v148 offset:18464
  ds_read_b64_tr_b16 v[138:139], v148 offset:20000
  v_mfma_f32_32x32x16_bf16 v[24:39], v[116:119], v[104:107], v[24:39]
  ds_read_b64_tr_b16 v[140:141], v149 offset:6144
  ds_read_b64_tr_b16 v[142:143], v149 offset:7680
  v_mfma_f32_32x32x16_bf16 v[72:87], v[116:119], v[108:111], v[72:87]
  v_mfma_f32_32x32x16_bf16 v[40:55], v[120:123], v[104:107], v[40:55]
  v_mfma_f32_32x32x16_bf16 v[88:103], v[120:123], v[108:111], v[88:103]
  s_cmp_eq_u32 s56, 1
  s_cbranch_scc0 L_vw_36
  s_waitcnt vmcnt(0)
L_vw_36:
  s_waitcnt lgkmcnt(0)
  s_barrier
  s_cmp_eq_u32 s56, 1
  s_cbranch_scc0 L_wf_37
  v_readfirstlane_b32 s11, v166
  s_nop 0
  s_cmp_eq_u32 s11, 0
  s_cbranch_scc0 L_tg_38
  v_mov_b32 v2, 0
  s_mov_b32 s64, 0
L_tag_39:
  global_load_dword v1, v2, s[34:35] sc1
  s_waitcnt vmcnt(0)
  v_readfirstlane_b32 s11, v1
  s_add_u32 s64, s64, 1
  s_cmp_gt_u32 s64, 200000
  s_cbranch_scc1 L_tagd_40
  s_cmp_eq_u32 s11, 0
  s_cbranch_scc0 L_tagd_40
  s_sleep 1
  s_branch L_tag_39
L_tagd_40:
L_tg_38:
  s_cmp_eq_u32 s3, 0
  s_cbranch_scc0 L_sf_41
  s_lshl_b32 s12, s4, 3
  s_add_u32 s12, s12, s5
  s_lshl_b32 s12, s12, 7
  s_add_u32 s12, s12, 49152
  v_mov_b32 v1, s12
  v_mov_b32 v2, s11
  s_mov_b64 s[62:63], exec
  s_mov_b64 exec, 1
  global_store_dword v1, v2, s[36:37] sc1
  s_mov_b64 exec, s[62:63]
L_sf_41:
L_wf_37:
  s_waitcnt lgkmcnt(0)
  v_mfma_f32_32x32x16_bf16 v[8:23], v[132:135], v[124:127], v[8:23]
  s_add_u32 s57, s57, 1
  s_cmp_eq_u32 s57, 4
  s_cselect_b32 s65, 4294893376, s80
  s_cselect_b32 s57, 0, s57
  v_add_u32 v148, s65, v148
  v_add_u32 v149, s65, v149
  ds_read_b128 v[104:107], v146
  ds_read_b128 v[108:111], v146 offset:4096
  ds_read_b64_tr_b16 v[112:113], v148 offset:0
  v_mfma_f32_32x32x16_bf16 v[56:71], v[132:135], v[128:131], v[56:71]
  ds_read_b64_tr_b16 v[114:115], v148 offset:1536
  ds_read_b64_tr_b16 v[116:117], v148 offset:12320
  ds_read_b64_tr_b16 v[118:119], v148 offset:13856
  v_mfma_f32_32x32x16_bf16 v[24:39], v[136:139], v[124:127], v[24:39]
  ds_read_b64_tr_b16 v[120:121], v149 offset:0
  ds_read_b64_tr_b16 v[122:123], v149 offset:1536
  v_mfma_f32_32x32x16_bf16 v[72:87], v[136:139], v[128:131], v[72:87]
  v_mfma_f32_32x32x16_bf16 v[40:55], v[140:143], v[124:127], v[40:55]
  v_mfma_f32_32x32x16_bf16 v[88:103], v[140:143], v[128:131], v[88:103]
  s_waitcnt lgkmcnt(0)
  v_mfma_f32_32x32x16_bf16 v[8:23], v[112:115], v[104:107], v[8:23]
  ds_read_b128 v[124:127], v147
  ds_read_b128 v[128:131], v147 offset:4096
  ds_read_b64_tr_b16 v[132:133], v148 offset:6144
  v_mfma_f32_32x32x16_bf16 v[56:71], v[112:115], v[108:111], v[56:71]
  ds_read_b64_tr_b16 v[134:135], v148 offset:7680
  ds_read_b64_tr_b16 v[136:137], v148 offset:18464
  ds_read_b64_tr_b16 v[138:139], v148 offset:20000
  v_mfma_f32_32x32x16_bf16 v[24:39], v[116:119], v[104:107], v[24:39]
  ds_read_b64_tr_b16 v[140:141], v149 offset:6144
  ds_read_b64_tr_b16 v[142:143], v149 offset:7680
  v_mfma_f32_32x32x16_bf16 v[72:87], v[116:119], v[108:111], v[72:87]
  v_mfma_f32_32x32x16_bf16 v[40:55], v[120:123], v[104:107], v[40:55]
  v_mfma_f32_32x32x16_bf16 v[88:103], v[120:123], v[108:111], v[88:103]
  s_waitcnt lgkmcnt(0)
  s_barrier
  s_waitcnt lgkmcnt(0)
  v_mfma_f32_32x32x16_bf16 v[8:23], v[132:135], v[124:127], v[8:23]
  s_add_u32 s57, s57, 1
  s_cmp_eq_u32 s57, 4
  s_cselect_b32 s65, 4294893376, s80
  s_cselect_b32 s57, 0, s57
  v_add_u32 v148, s65, v148
  v_add_u32 v149, s65, v149
  s_add_u32 s58, s58, 1
  s_cmp_eq_u32 s58, 3
  s_cselect_b32 s66, 4294934528, s81
  s_cselect_b32 s58, 0, s58
  v_add_u32 v144, s66, v144
  ds_read_b128 v[104:107], v144
  ds_read_b128 v[108:111], v144 offset:4096
  ds_read_b64_tr_b16 v[112:113], v148 offset:0
  v_mfma_f32_32x32x16_bf16 v[56:71], v[132:135], v[128:131], v[56:71]
  ds_read_b64_tr_b16 v[114:115], v148 offset:1536
  ds_read_b64_tr_b16 v[116:117], v148 offset:12320
  ds_read_b64_tr_b16 v[118:119], v148 offset:13856
  v_mfma_f32_32x32x16_bf16 v[24:39], v[136:139], v[124:127], v[24:39]
  ds_read_b64_tr_b16 v[120:121], v149 offset:0
  ds_read_b64_tr_b16 v[122:123], v149 offset:1536
  v_add_u32 v145, s66, v145
  v_mfma_f32_32x32x16_bf16 v[72:87], v[136:139], v[128:131], v[72:87]
  v_add_u32 v146, s66, v146
  v_add_u32 v147, s66, v147
  v_mfma_f32_32x32x16_bf16 v[40:55], v[140:143], v[124:127], v[40:55]
  v_mfma_f32_32x32x16_bf16 v[88:103], v[140:143], v[128:131], v[88:103]
  s_add_u32 s56, s56, 1
  s_cmp_lt_u32 s56, 10
  s_cbranch_scc1 L_main_35
  v_and_b32 v1, 31, v0
  s_lshl_b32 s13, s9, 6
  v_add_u32 v1, s13, v1
  v_lshlrev_b32 v1, 3, v1
  v_add_u32 v1, 147712, v1
  ds_read_b64 v[2:3], v1
  ds_read_b64 v[4:5], v1 offset:256
  s_mul_i32 s12, s10, 384
  s_add_u32 s12, s12, 148736
  v_lshrrev_b32 v6, 5, v0
  v_lshl_add_u32 v6, v6, 4, s12
  ds_read_b128 v[104:107], v6 offset:0
  ds_read_b128 v[108:111], v6 offset:32
  ds_read_b128 v[112:115], v6 offset:64
  ds_read_b128 v[116:119], v6 offset:96
  ds_read_b128 v[120:123], v6 offset:128
  ds_read_b128 v[124:127], v6 offset:160
  ds_read_b128 v[128:131], v6 offset:192
  ds_read_b128 v[132:135], v6 offset:224
  ds_read_b128 v[136:139], v6 offset:256
  ds_read_b128 v[140:143], v6 offset:288
  ds_read_b128 v[144:147], v6 offset:320
  ds_read_b128 v[148:151], v6 offset:352
  s_waitcnt lgkmcnt(12)
  s_mov_b32 s12, 0x3acccccd
  v_mul_f32 v2, s12, v2
  v_mul_f32 v3, s12, v3
  v_fma_f32 v3, -v2, v2, v3
  v_max_f32 v3, 0, v3
  v_add_f32 v3, 0x3727c5ac, v3
  v_rsq_f32 v164, v3
  v_sub_f32 v162, 0, v2
  v_mul_f32 v4, s12, v4
  v_mul_f32 v5, s12, v5
  v_fma_f32 v5, -v4, v4, v5
  v_max_f32 v5, 0, v5
  v_add_f32 v5, 0x3727c5ac, v5
  v_rsq_f32 v165, v5
  v_sub_f32 v163, 0, v4
  v_mov_b32 v154, v162
  v_mul_f32 v158, v164, v164
  v_mov_b32 v156, v163
  v_mul_f32 v160, v165, v165
  s_add_u32 s48, s36, 5242880
  s_addc_u32 s49, s37, 0
  s_mov_b32 s50, 8912896
  s_mov_b32 s51, 0x20000
  s_lshl_b32 s12, s4, 3
  s_lshl_b32 s13, s9, 2
  s_add_u32 s12, s12, s13
  v_bfe_u32 v2, v0, 4, 1
  v_add_u32 v2, s12, v2
  v_mul_u32_u24 v2, 69632, v2
  v_and_b32 v3, 15, v0
  v_lshl_add_u32 v2, v3, 4, v2
  v_lshrrev_b32 v3, 5, v0
  v_lshl_add_u32 v2, v3, 9, v2
  v_add_u32 v3, 139264, v2
  s_mul_i32 s12, s5, 6
  s_add_u32 s13, s12, s10
  s_lshl_b32 s13, s13, 10
  s_lshr_b32 s14, s10, 1
  s_add_u32 s14, s14, s12
  s_add_u32 s14, s14, 4
  s_lshl_b32 s14, s14, 10
  s_and_b32 s15, s10, 1
  s_lshl_b32 s15, s15, 8
  s_add_u32 s14, s14, s15
  s_waitcnt lgkmcnt(0)
  v_fmac_f32 v8, v154, v104
  v_fmac_f32 v24, v154, v120
  v_fmac_f32 v9, v154, v105
  v_fmac_f32 v25, v154, v121
  v_fmac_f32 v10, v154, v106
  v_fmac_f32 v26, v154, v122
  v_fmac_f32 v11, v154, v107
  v_fmac_f32 v27, v154, v123
  v_fmac_f32 v12, v154, v108
  v_fmac_f32 v28, v154, v124
  v_fmac_f32 v13, v154, v109
  v_fmac_f32 v29, v154, v125
  v_fmac_f32 v14, v154, v110
  v_fmac_f32 v30, v154, v126
  v_fmac_f32 v15, v154, v111
  v_fmac_f32 v31, v154, v127
  v_fmac_f32 v16, v154, v112
  v_fmac_f32 v32, v154, v128
  v_fmac_f32 v17, v154, v113
  v_fmac_f32 v33, v154, v129
  v_fmac_f32 v18, v154, v114
  v_fmac_f32 v34, v154, v130
  v_fmac_f32 v19, v154, v115
  v_fmac_f32 v35, v154, v131
  v_fmac_f32 v20, v154, v116
  v_fmac_f32 v36, v154, v132
  v_fmac_f32 v21, v154, v117
  v_fmac_f32 v37, v154, v133
  v_fmac_f32 v22, v154, v118
  v_fmac_f32 v38, v154, v134
  v_fmac_f32 v23, v154, v119
  v_fmac_f32 v39, v154, v135
  v_mul_f32 v8, v158, v8
  v_mul_f32 v9, v158, v9
  v_mul_f32 v10, v158, v10
  v_mul_f32 v11, v158, v11
  v_mul_f32 v12, v158, v12
  v_mul_f32 v13, v158, v13
  v_mul_f32 v14, v158, v14
  v_mul_f32 v15, v158, v15
  v_mul_f32 v16, v158, v16
  v_mul_f32 v17, v158, v17
  v_mul_f32 v18, v158, v18
  v_mul_f32 v19, v158, v19
  v_mul_f32 v20, v158, v20
  v_mul_f32 v21, v158, v21
  v_mul_f32 v22, v158, v22
  v_mul_f32 v23, v158, v23
  v_mul_f32 v8, v8, v24
  v_mul_f32 v9, v9, v25
  v_mul_f32 v10, v10, v26
  v_mul_f32 v11, v11, v27
  v_mul_f32 v12, v12, v28
  v_mul_f32 v13, v13, v29
  v_mul_f32 v14, v14, v30
  v_mul_f32 v15, v15, v31
  v_mul_f32 v16, v16, v32
  v_mul_f32 v17, v17, v33
  v_mul_f32 v18, v18, v34
  v_mul_f32 v19, v19, v35
  v_mul_f32 v20, v20, v36
  v_mul_f32 v21, v21, v37
  v_mul_f32 v22, v22, v38
  v_mul_f32 v23, v23, v39
  v_cvt_pk_bf16_f32 v24, v8, v9
  v_cvt_pk_bf16_f32 v25, v10, v11
  v_cvt_pk_bf16_f32 v26, v12, v13
  v_cvt_pk_bf16_f32 v27, v14, v15
  v_cvt_pk_bf16_f32 v28, v16, v17
  v_cvt_pk_bf16_f32 v29, v18, v19
  v_cvt_pk_bf16_f32 v30, v20, v21
  v_cvt_pk_bf16_f32 v31, v22, v23
  buffer_store_dwordx4 v[24:27], v2, s[48:51], s13 offen sc1
  buffer_store_dwordx4 v[28:31], v2, s[48:51], s13 offen offset:256 sc1
  v_fmac_f32 v40, v154, v136
  v_fmac_f32 v41, v154, v137
  v_fmac_f32 v42, v154, v138
  v_fmac_f32 v43, v154, v139
  v_fmac_f32 v44, v154, v140
  v_fmac_f32 v45, v154, v141
  v_fmac_f32 v46, v154, v142
  v_fmac_f32 v47, v154, v143
  v_fmac_f32 v48, v154, v144
  v_fmac_f32 v49, v154, v145
  v_fmac_f32 v50, v154, v146
  v_fmac_f32 v51, v154, v147
  v_fmac_f32 v52, v154, v148
  v_fmac_f32 v53, v154, v149
  v_fmac_f32 v54, v154, v150
  v_fmac_f32 v55, v154, v151
  v_mul_f32 v40, v158, v40
  v_mul_f32 v41, v158, v41
  v_mul_f32 v42, v158, v42
  v_mul_f32 v43, v158, v43
  v_mul_f32 v44, v158, v44
  v_mul_f32 v45, v158, v45
  v_mul_f32 v46, v158, v46
  v_mul_f32 v47, v158, v47
  v_mul_f32 v40, v40, v48
  v_mul_f32 v41, v41, v49
  v_mul_f32 v42, v42, v50
  v_mul_f32 v43, v43, v51
  v_mul_f32 v44, v44, v52
  v_mul_f32 v45, v45, v53
  v_mul_f32 v46, v46, v54
  v_mul_f32 v47, v47, v55
  v_cvt_pk_bf16_f32 v48, v40, v41
  v_cvt_pk_bf16_f32 v49, v42, v43
  v_cvt_pk_bf16_f32 v50, v44, v45
  v_cvt_pk_bf16_f32 v51, v46, v47
  buffer_store_dwordx4 v[48:51], v2, s[48:51], s14 offen sc1
  v_fmac_f32 v56, v156, v104
  v_fmac_f32 v72, v156, v120
  v_fmac_f32 v57, v156, v105
  v_fmac_f32 v73, v156, v121
  v_fmac_f32 v58, v156, v106
  v_fmac_f32 v74, v156, v122
  v_fmac_f32 v59, v156, v107
  v_fmac_f32 v75, v156, v123
  v_fmac_f32 v60, v156, v108
  v_fmac_f32 v76, v156, v124
  v_fmac_f32 v61, v156, v109
  v_fmac_f32 v77, v156, v125
  v_fmac_f32 v62, v156, v110
  v_fmac_f32 v78, v156, v126
  v_fmac_f32 v63, v156, v111
  v_fmac_f32 v79, v156, v127
  v_fmac_f32 v64, v156, v112
  v_fmac_f32 v80, v156, v128
  v_fmac_f32 v65, v156, v113
  v_fmac_f32 v81, v156, v129
  v_fmac_f32 v66, v156, v114
  v_fmac_f32 v82, v156, v130
  v_fmac_f32 v67, v156, v115
  v_fmac_f32 v83, v156, v131
  v_fmac_f32 v68, v156, v116
  v_fmac_f32 v84, v156, v132
  v_fmac_f32 v69, v156, v117
  v_fmac_f32 v85, v156, v133
  v_fmac_f32 v70, v156, v118
  v_fmac_f32 v86, v156, v134
  v_fmac_f32 v71, v156, v119
  v_fmac_f32 v87, v156, v135
  v_mul_f32 v56, v160, v56
  v_mul_f32 v57, v160, v57
  v_mul_f32 v58, v160, v58
  v_mul_f32 v59, v160, v59
  v_mul_f32 v60, v160, v60
  v_mul_f32 v61, v160, v61
  v_mul_f32 v62, v160, v62
  v_mul_f32 v63, v160, v63
  v_mul_f32 v64, v160, v64
  v_mul_f32 v65, v160, v65
  v_mul_f32 v66, v160, v66
  v_mul_f32 v67, v160, v67
  v_mul_f32 v68, v160, v68
  v_mul_f32 v69, v160, v69
  v_mul_f32 v70, v160, v70
  v_mul_f32 v71, v160, v71
  v_mul_f32 v56, v56, v72
  v_mul_f32 v57, v57, v73
  v_mul_f32 v58, v58, v74
  v_mul_f32 v59, v59, v75
  v_mul_f32 v60, v60, v76
  v_mul_f32 v61, v61, v77
  v_mul_f32 v62, v62, v78
  v_mul_f32 v63, v63, v79
  v_mul_f32 v64, v64, v80
  v_mul_f32 v65, v65, v81
  v_mul_f32 v66, v66, v82
  v_mul_f32 v67, v67, v83
  v_mul_f32 v68, v68, v84
  v_mul_f32 v69, v69, v85
  v_mul_f32 v70, v70, v86
  v_mul_f32 v71, v71, v87
  v_cvt_pk_bf16_f32 v72, v56, v57
  v_cvt_pk_bf16_f32 v73, v58, v59
  v_cvt_pk_bf16_f32 v74, v60, v61
  v_cvt_pk_bf16_f32 v75, v62, v63
  v_cvt_pk_bf16_f32 v76, v64, v65
  v_cvt_pk_bf16_f32 v77, v66, v67
  v_cvt_pk_bf16_f32 v78, v68, v69
  v_cvt_pk_bf16_f32 v79, v70, v71
  buffer_store_dwordx4 v[72:75], v3, s[48:51], s13 offen sc1
  buffer_store_dwordx4 v[76:79], v3, s[48:51], s13 offen offset:256 sc1
  v_fmac_f32 v88, v156, v136
  v_fmac_f32 v89, v156, v137
  v_fmac_f32 v90, v156, v138
  v_fmac_f32 v91, v156, v139
  v_fmac_f32 v92, v156, v140
  v_fmac_f32 v93, v156, v141
  v_fmac_f32 v94, v156, v142
  v_fmac_f32 v95, v156, v143
  v_fmac_f32 v96, v156, v144
  v_fmac_f32 v97, v156, v145
  v_fmac_f32 v98, v156, v146
  v_fmac_f32 v99, v156, v147
  v_fmac_f32 v100, v156, v148
  v_fmac_f32 v101, v156, v149
  v_fmac_f32 v102, v156, v150
  v_fmac_f32 v103, v156, v151
  v_mul_f32 v88, v160, v88
  v_mul_f32 v89, v160, v89
  v_mul_f32 v90, v160, v90
  v_mul_f32 v91, v160, v91
  v_mul_f32 v92, v160, v92
  v_mul_f32 v93, v160, v93
  v_mul_f32 v94, v160, v94
  v_mul_f32 v95, v160, v95
  v_mul_f32 v88, v88, v96
  v_mul_f32 v89, v89, v97
  v_mul_f32 v90, v90, v98
  v_mul_f32 v91, v91, v99
  v_mul_f32 v92, v92, v100
  v_mul_f32 v93, v93, v101
  v_mul_f32 v94, v94, v102
  v_mul_f32 v95, v95, v103
  v_cvt_pk_bf16_f32 v96, v88, v89
  v_cvt_pk_bf16_f32 v97, v90, v91
  v_cvt_pk_bf16_f32 v98, v92, v93
  v_cvt_pk_bf16_f32 v99, v94, v95
  buffer_store_dwordx4 v[96:99], v3, s[48:51], s14 offen sc1
  s_lshl_b32 s12, s4, 3
  s_add_u32 s12, s12, s5
  s_lshl_b32 s12, s12, 3
  s_add_u32 s12, s12, s3
  s_lshl_b32 s12, s12, 7
  s_add_u32 s12, s12, 14680064
  s_waitcnt vmcnt(0)
  v_mov_b32 v1, s12
  v_mov_b32 v2, s11
  s_mov_b64 s[62:63], exec
  s_mov_b64 exec, 1
  global_store_dword v1, v2, s[36:37] sc1
  s_mov_b64 exec, s[62:63]
  s_add_u32 s44, s36, 5242880
  s_addc_u32 s45, s37, 0
  s_mov_b32 s46, 8912896
  s_mov_b32 s47, 0x20000
  s_lshl_b32 s12, s7, 2
  s_lshl_b32 s13, s9, 1
  s_add_u32 s12, s12, s13
  s_mul_i32 s12, s12, 69632
  v_lshl_add_u32 v150, v0, 4, s12
  v_add_u32 v151, 69632, v150
  s_mul_i32 s86, s10, 12288
  s_mul_i32 s87, s10, 5120
  s_add_u32 s87, s87, 49152
  s_mov_b32 s52, s16
  s_mov_b32 s53, s17
  s_mov_b32 s54, 2621440
  s_mov_b32 s55, 0x20000
  v_and_b32 v4, 15, v0
  s_lshl_b32 s12, s7, 6
  s_lshl_b32 s13, s9, 5
  s_add_u32 s12, s12, s13
  v_add_u32 v4, s12, v4
  v_mul_u32_u24 v4, 1280, v4
  v_lshrrev_b32 v5, 4, v0
  v_lshl_add_u32 v4, v5, 3, v4
  s_mul_i32 s12, s8, 160
  v_add_u32 v4, s12, v4
  s_add_u32 s12, s10, 0
  s_cmp_ge_u32 s12, 5
  s_cselect_b32 s13, 20320, 0
  s_lshl_b32 s12, s12, 5
  s_add_u32 s96, s12, s13
  s_add_u32 s12, s10, 4
  s_cmp_ge_u32 s12, 5
  s_cselect_b32 s13, 20320, 0
  s_lshl_b32 s12, s12, 5
  s_add_u32 s97, s12, s13
  s_add_u32 s12, s10, 8
  s_cmp_ge_u32 s12, 5
  s_cselect_b32 s13, 20320, 0
  s_lshl_b32 s12, s12, 5
  s_add_u32 s98, s12, s13
  s_mul_i32 s12, s10, 10240
  v_lshl_add_u32 v6, v0, 4, s12
  v_mov_b32 v8, 0
  v_mov_b32 v9, 0
  v_mov_b32 v10, 0
  v_mov_b32 v11, 0
  v_mov_b32 v12, 0
  v_mov_b32 v13, 0
  v_mov_b32 v14, 0
  v_mov_b32 v15, 0
  v_mov_b32 v16, 0
  v_mov_b32 v17, 0
  v_mov_b32 v18, 0
  v_mov_b32 v19, 0
  v_mov_b32 v20, 0
  v_mov_b32 v21, 0
  v_mov_b32 v22, 0
  v_mov_b32 v23, 0
  v_mov_b32 v24, 0
  v_mov_b32 v25, 0
  v_mov_b32 v26, 0
  v_mov_b32 v27, 0
  v_mov_b32 v28, 0
  v_mov_b32 v29, 0
  v_mov_b32 v30, 0
  v_mov_b32 v31, 0
  v_mov_b32 v32, 0
  v_mov_b32 v33, 0
  v_mov_b32 v34, 0
  v_mov_b32 v35, 0
  v_mov_b32 v36, 0
  v_mov_b32 v37, 0
  v_mov_b32 v38, 0
  v_mov_b32 v39, 0
  v_mov_b32 v40, 0
  v_mov_b32 v41, 0
  v_mov_b32 v42, 0
  v_mov_b32 v43, 0
  v_mov_b32 v44, 0
  v_mov_b32 v45, 0
  v_mov_b32 v46, 0
  v_mov_b32 v47, 0
  v_and_b32 v29, 7, v0
  v_lshrrev_b32 v5, 2, v29
  s_lshr_b32 s12, s7, 1
  s_lshl_b32 s12, s12, 3
  s_lshl_b32 s13, s10, 1
  s_add_u32 s12, s12, s13
  v_add_u32 v5, s12, v5
  v_lshlrev_b32 v5, 3, v5
  v_and_b32 v29, 3, v29
  s_and_b32 s13, s7, 1
  s_lshl_b32 s14, s13, 2
  v_add_u32 v7, s14, v29
  v_add_u32 v7, v7, v5
  v_lshlrev_b32 v7, 7, v7
  v_add_u32 v160, 14680064, v7
  v_lshlrev_b32 v29, 1, v29
  v_add_u32 v29, s13, v29
  v_add_u32 v29, v29, v5
  v_lshlrev_b32 v29, 7, v29
  v_add_u32 v161, 14942208, v29
  s_mov_b32 s64, 0
  s_waitcnt vmcnt(0)
  global_load_dword v7, v160, s[36:37] sc1
  s_sleep 4
  global_load_dword v1, v160, s[36:37] sc1
L_poll_42:
  s_waitcnt vmcnt(1)
  v_cmp_ne_u32 vcc, s11, v7
  s_cbranch_vccz L_polld_43
  s_sleep 6
  global_load_dword v7, v160, s[36:37] sc1
  s_waitcnt vmcnt(1)
  v_cmp_ne_u32 vcc, s11, v1
  s_cbranch_vccz L_polld_43
  s_sleep 6
  global_load_dword v1, v160, s[36:37] sc1
  s_add_u32 s64, s64, 1
  s_cmp_gt_u32 s64, 200000
  s_cbranch_scc0 L_poll_42
L_polld_43:
  s_waitcnt vmcnt(0)
  s_add_u32 s60, s86, 0
  buffer_load_dwordx4 v[88:91], v150, s[44:47], s60 offen sc1
  buffer_load_dwordx4 v[92:95], v151, s[44:47], s60 offen sc1
  s_add_u32 s60, s86, 1024
  buffer_load_dwordx4 v[96:99], v150, s[44:47], s60 offen sc1
  buffer_load_dwordx4 v[100:103], v151, s[44:47], s60 offen sc1
  s_add_u32 s60, s86, 2048
  buffer_load_dwordx4 v[104:107], v150, s[44:47], s60 offen sc1
  buffer_load_dwordx4 v[108:111], v151, s[44:47], s60 offen sc1
  s_add_u32 s60, s86, 3072
  buffer_load_dwordx4 v[112:115], v150, s[44:47], s60 offen sc1
  buffer_load_dwordx4 v[116:119], v151, s[44:47], s60 offen sc1
  s_add_u32 s60, s86, 4096
  buffer_load_dwordx4 v[120:123], v150, s[44:47], s60 offen sc1
  buffer_load_dwordx4 v[124:127], v151, s[44:47], s60 offen sc1
  s_barrier
  v_add_u32 v7, 0, v6
  ds_read_b128 v[48:51], v7 offset:0
  ds_read_b128 v[52:55], v7 offset:1024
  ds_read_b128 v[56:59], v7 offset:2048
  ds_read_b128 v[60:63], v7 offset:3072
  ds_read_b128 v[64:67], v7 offset:4096
  s_waitcnt vmcnt(8) lgkmcnt(0)
  v_mfma_f32_16x16x32_bf16 v[8:11], v[48:51], v[88:91], v[8:11]
  v_add_u32 v7, 5120, v6
  v_mfma_f32_16x16x32_bf16 v[28:31], v[48:51], v[92:95], v[28:31]
  ds_read_b128 v[68:71], v7 offset:0
  v_mfma_f32_16x16x32_bf16 v[12:15], v[52:55], v[88:91], v[12:15]
  ds_read_b128 v[72:75], v7 offset:1024
  v_mfma_f32_16x16x32_bf16 v[32:35], v[52:55], v[92:95], v[32:35]
  ds_read_b128 v[76:79], v7 offset:2048
  v_mfma_f32_16x16x32_bf16 v[16:19], v[56:59], v[88:91], v[16:19]
  ds_read_b128 v[80:83], v7 offset:3072
  v_mfma_f32_16x16x32_bf16 v[36:39], v[56:59], v[92:95], v[36:39]
  ds_read_b128 v[84:87], v7 offset:4096
  v_mfma_f32_16x16x32_bf16 v[20:23], v[60:63], v[88:91], v[20:23]
  v_mfma_f32_16x16x32_bf16 v[40:43], v[60:63], v[92:95], v[40:43]
  v_mfma_f32_16x16x32_bf16 v[24:27], v[64:67], v[88:91], v[24:27]
  v_mfma_f32_16x16x32_bf16 v[44:47], v[64:67], v[92:95], v[44:47]
  s_add_u32 s60, s86, 5120
  buffer_load_dwordx4 v[88:91], v150, s[44:47], s60 offen sc1
  buffer_load_dwordx4 v[92:95], v151, s[44:47], s60 offen sc1
  s_waitcnt lgkmcnt(0)
  s_waitcnt vmcnt(8)
  v_mfma_f32_16x16x32_bf16 v[8:11], v[68:71], v[96:99], v[8:11]
  v_add_u32 v7, 40960, v6
  v_mfma_f32_16x16x32_bf16 v[28:31], v[68:71], v[100:103], v[28:31]
  ds_read_b128 v[48:51], v7 offset:0
  v_mfma_f32_16x16x32_bf16 v[12:15], v[72:75], v[96:99], v[12:15]
  ds_read_b128 v[52:55], v7 offset:1024
  v_mfma_f32_16x16x32_bf16 v[32:35], v[72:75], v[100:103], v[32:35]
  ds_read_b128 v[56:59], v7 offset:2048
  v_mfma_f32_16x16x32_bf16 v[16:19], v[76:79], v[96:99], v[16:19]
  ds_read_b128 v[60:63], v7 offset:3072
  v_mfma_f32_16x16x32_bf16 v[36:39], v[76:79], v[100:103], v[36:39]
  ds_read_b128 v[64:67], v7 offset:4096
  v_mfma_f32_16x16x32_bf16 v[20:23], v[80:83], v[96:99], v[20:23]
  v_mfma_f32_16x16x32_bf16 v[40:43], v[80:83], v[100:103], v[40:43]
  v_mfma_f32_16x16x32_bf16 v[24:27], v[84:87], v[96:99], v[24:27]
  v_mfma_f32_16x16x32_bf16 v[44:47], v[84:87], v[100:103], v[44:47]
  s_add_u32 s60, s86, 6144
  buffer_load_dwordx4 v[96:99], v150, s[44:47], s60 offen sc1
  buffer_load_dwordx4 v[100:103], v151, s[44:47], s60 offen sc1
  s_waitcnt vmcnt(8) lgkmcnt(0)
  v_mfma_f32_16x16x32_bf16 v[8:11], v[48:51], v[104:107], v[8:11]
  v_add_u32 v7, 46080, v6
  v_mfma_f32_16x16x32_bf16 v[28:31], v[48:51], v[108:111], v[28:31]
  ds_read_b128 v[68:71], v7 offset:0
  v_mfma_f32_16x16x32_bf16 v[12:15], v[52:55], v[104:107], v[12:15]
  ds_read_b128 v[72:75], v7 offset:1024
  v_mfma_f32_16x16x32_bf16 v[32:35], v[52:55], v[108:111], v[32:35]
  ds_read_b128 v[76:79], v7 offset:2048
  v_mfma_f32_16x16x32_bf16 v[16:19], v[56:59], v[104:107], v[16:19]
  ds_read_b128 v[80:83], v7 offset:3072
  v_mfma_f32_16x16x32_bf16 v[36:39], v[56:59], v[108:111], v[36:39]
  ds_read_b128 v[84:87], v7 offset:4096
  v_mfma_f32_16x16x32_bf16 v[20:23], v[60:63], v[104:107], v[20:23]
  v_mfma_f32_16x16x32_bf16 v[40:43], v[60:63], v[108:111], v[40:43]
  v_mfma_f32_16x16x32_bf16 v[24:27], v[64:67], v[104:107], v[24:27]
  v_mfma_f32_16x16x32_bf16 v[44:47], v[64:67], v[108:111], v[44:47]
  s_add_u32 s60, s86, 7168
  buffer_load_dwordx4 v[104:107], v150, s[44:47], s60 offen sc1
  buffer_load_dwordx4 v[108:111], v151, s[44:47], s60 offen sc1
  s_waitcnt lgkmcnt(0)
  s_barrier
  s_waitcnt vmcnt(8)
  v_mfma_f32_16x16x32_bf16 v[8:11], v[68:71], v[112:115], v[8:11]
  v_add_u32 v7, 81920, v6
  v_mfma_f32_16x16x32_bf16 v[28:31], v[68:71], v[116:119], v[28:31]
  ds_read_b128 v[48:51], v7 offset:0
  v_mfma_f32_16x16x32_bf16 v[12:15], v[72:75], v[112:115], v[12:15]
  ds_read_b128 v[52:55], v7 offset:1024
  v_mfma_f32_16x16x32_bf16 v[32:35], v[72:75], v[116:119], v[32:35]
  ds_read_b128 v[56:59], v7 offset:2048
  v_mfma_f32_16x16x32_bf16 v[16:19], v[76:79], v[112:115], v[16:19]
  ds_read_b128 v[60:63], v7 offset:3072
  v_mfma_f32_16x16x32_bf16 v[36:39], v[76:79], v[116:119], v[36:39]
  ds_read_b128 v[64:67], v7 offset:4096
  v_mfma_f32_16x16x32_bf16 v[20:23], v[80:83], v[112:115], v[20:23]
  v_mfma_f32_16x16x32_bf16 v[40:43], v[80:83], v[116:119], v[40:43]
  v_mfma_f32_16x16x32_bf16 v[24:27], v[84:87], v[112:115], v[24:27]
  v_mfma_f32_16x16x32_bf16 v[44:47], v[84:87], v[116:119], v[44:47]
  s_add_u32 s60, s86, 8192
  buffer_load_dwordx4 v[112:115], v150, s[44:47], s60 offen sc1
  buffer_load_dwordx4 v[116:119], v151, s[44:47], s60 offen sc1
  s_waitcnt vmcnt(8) lgkmcnt(0)
  v_mfma_f32_16x16x32_bf16 v[8:11], v[48:51], v[120:123], v[8:11]
  v_add_u32 v7, 87040, v6
  v_mfma_f32_16x16x32_bf16 v[28:31], v[48:51], v[124:127], v[28:31]
  ds_read_b128 v[68:71], v7 offset:0
  v_mfma_f32_16x16x32_bf16 v[12:15], v[52:55], v[120:123], v[12:15]
  ds_read_b128 v[72:75], v7 offset:1024
  v_mfma_f32_16x16x32_bf16 v[32:35], v[52:55], v[124:127], v[32:35]
  ds_read_b128 v[76:79], v7 offset:2048
  v_mfma_f32_16x16x32_bf16 v[16:19], v[56:59], v[120:123], v[16:19]
  ds_read_b128 v[80:83], v7 offset:3072
  v_mfma_f32_16x16x32_bf16 v[36:39], v[56:59], v[124:127], v[36:39]
  ds_read_b128 v[84:87], v7 offset:4096
  v_mfma_f32_16x16x32_bf16 v[20:23], v[60:63], v[120:123], v[20:23]
  v_mfma_f32_16x16x32_bf16 v[40:43], v[60:63], v[124:127], v[40:43]
  v_mfma_f32_16x16x32_bf16 v[24:27], v[64:67], v[120:123], v[24:27]
  v_mfma_f32_16x16x32_bf16 v[44:47], v[64:67], v[124:127], v[44:47]
  s_add_u32 s60, s86, 9216
  buffer_load_dwordx4 v[120:123], v150, s[44:47], s60 offen sc1
  buffer_load_dwordx4 v[124:127], v151, s[44:47], s60 offen sc1
  s_waitcnt lgkmcnt(0)
  s_waitcnt vmcnt(8)
  v_mfma_f32_16x16x32_bf16 v[8:11], v[68:71], v[88:91], v[8:11]
  v_add_u32 v7, 122880, v6
  v_mfma_f32_16x16x32_bf16 v[28:31], v[68:71], v[92:95], v[28:31]
  ds_read_b128 v[48:51], v7 offset:0
  v_mfma_f32_16x16x32_bf16 v[12:15], v[72:75], v[88:91], v[12:15]
  ds_read_b128 v[52:55], v7 offset:1024
  v_mfma_f32_16x16x32_bf16 v[32:35], v[72:75], v[92:95], v[32:35]
  ds_read_b128 v[56:59], v7 offset:2048
  v_mfma_f32_16x16x32_bf16 v[16:19], v[76:79], v[88:91], v[16:19]
  ds_read_b128 v[60:63], v7 offset:3072
  v_mfma_f32_16x16x32_bf16 v[36:39], v[76:79], v[92:95], v[36:39]
  ds_read_b128 v[64:67], v7 offset:4096
  v_mfma_f32_16x16x32_bf16 v[20:23], v[80:83], v[88:91], v[20:23]
  v_mfma_f32_16x16x32_bf16 v[40:43], v[80:83], v[92:95], v[40:43]
  v_mfma_f32_16x16x32_bf16 v[24:27], v[84:87], v[88:91], v[24:27]
  v_mfma_f32_16x16x32_bf16 v[44:47], v[84:87], v[92:95], v[44:47]
  s_add_u32 s60, s86, 10240
  buffer_load_dwordx4 v[88:91], v150, s[44:47], s60 offen sc1
  buffer_load_dwordx4 v[92:95], v151, s[44:47], s60 offen sc1
  s_waitcnt vmcnt(8) lgkmcnt(0)
  v_mfma_f32_16x16x32_bf16 v[8:11], v[48:51], v[96:99], v[8:11]
  v_add_u32 v7, 128000, v6
  v_mfma_f32_16x16x32_bf16 v[28:31], v[48:51], v[100:103], v[28:31]
  ds_read_b128 v[68:71], v7 offset:0
  v_mfma_f32_16x16x32_bf16 v[12:15], v[52:55], v[96:99], v[12:15]
  ds_read_b128 v[72:75], v7 offset:1024
  v_mfma_f32_16x16x32_bf16 v[32:35], v[52:55], v[100:103], v[32:35]
  ds_read_b128 v[76:79], v7 offset:2048
  v_mfma_f32_16x16x32_bf16 v[16:19], v[56:59], v[96:99], v[16:19]
  ds_read_b128 v[80:83], v7 offset:3072
  v_mfma_f32_16x16x32_bf16 v[36:39], v[56:59], v[100:103], v[36:39]
  ds_read_b128 v[84:87], v7 offset:4096
  v_mfma_f32_16x16x32_bf16 v[20:23], v[60:63], v[96:99], v[20:23]
  v_mfma_f32_16x16x32_bf16 v[40:43], v[60:63], v[100:103], v[40:43]
  v_mfma_f32_16x16x32_bf16 v[24:27], v[64:67], v[96:99], v[24:27]
  v_mfma_f32_16x16x32_bf16 v[44:47], v[64:67], v[100:103], v[44:47]
  s_add_u32 s60, s86, 11264
  buffer_load_dwordx4 v[96:99], v150, s[44:47], s60 offen sc1
  buffer_load_dwordx4 v[100:103], v151, s[44:47], s60 offen sc1
  s_waitcnt lgkmcnt(0)
  s_barrier
  s_waitcnt vmcnt(8)
  v_mfma_f32_16x16x32_bf16 v[8:11], v[68:71], v[104:107], v[8:11]
  v_add_u32 v7, 0, v6
  v_mfma_f32_16x16x32_bf16 v[28:31], v[68:71], v[108:111], v[28:31]
  ds_read_b128 v[48:51], v7 offset:0
  v_mfma_f32_16x16x32_bf16 v[12:15], v[72:75], v[104:107], v[12:15]
  ds_read_b128 v[52:55], v7 offset:1024
  v_mfma_f32_16x16x32_bf16 v[32:35], v[72:75], v[108:111], v[32:35]
  ds_read_b128 v[56:59], v7 offset:2048
  v_mfma_f32_16x16x32_bf16 v[16:19], v[76:79], v[104:107], v[16:19]
  ds_read_b128 v[60:63], v7 offset:3072
  v_mfma_f32_16x16x32_bf16 v[36:39], v[76:79], v[108:111], v[36:39]
  ds_read_b128 v[64:67], v7 offset:4096
  v_mfma_f32_16x16x32_bf16 v[20:23], v[80:83], v[104:107], v[20:23]
  v_mfma_f32_16x16x32_bf16 v[40:43], v[80:83], v[108:111], v[40:43]
  v_mfma_f32_16x16x32_bf16 v[24:27], v[84:87], v[104:107], v[24:27]
  v_mfma_f32_16x16x32_bf16 v[44:47], v[84:87], v[108:111], v[44:47]
  s_waitcnt vmcnt(6) lgkmcnt(0)
  v_mfma_f32_16x16x32_bf16 v[8:11], v[48:51], v[112:115], v[8:11]
  v_add_u32 v7, 5120, v6
  v_mfma_f32_16x16x32_bf16 v[28:31], v[48:51], v[116:119], v[28:31]
  ds_read_b128 v[68:71], v7 offset:0
  v_mfma_f32_16x16x32_bf16 v[12:15], v[52:55], v[112:115], v[12:15]
  ds_read_b128 v[72:75], v7 offset:1024
  v_mfma_f32_16x16x32_bf16 v[32:35], v[52:55], v[116:119], v[32:35]
  ds_read_b128 v[76:79], v7 offset:2048
  v_mfma_f32_16x16x32_bf16 v[16:19], v[56:59], v[112:115], v[16:19]
  ds_read_b128 v[80:83], v7 offset:3072
  v_mfma_f32_16x16x32_bf16 v[36:39], v[56:59], v[116:119], v[36:39]
  ds_read_b128 v[84:87], v7 offset:4096
  v_mfma_f32_16x16x32_bf16 v[20:23], v[60:63], v[112:115], v[20:23]
  v_mfma_f32_16x16x32_bf16 v[40:43], v[60:63], v[116:119], v[40:43]
  v_mfma_f32_16x16x32_bf16 v[24:27], v[64:67], v[112:115], v[24:27]
  v_mfma_f32_16x16x32_bf16 v[44:47], v[64:67], v[116:119], v[44:47]
  s_waitcnt lgkmcnt(0)
  global_load_dword v152, v161, s[36:37] sc1
  s_waitcnt vmcnt(4)
  v_mfma_f32_16x16x32_bf16 v[8:11], v[68:71], v[120:123], v[8:11]
  v_add_u32 v7, 40960, v6
  v_mfma_f32_16x16x32_bf16 v[28:31], v[68:71], v[124:127], v[28:31]
  ds_read_b128 v[48:51], v7 offset:0
  v_mfma_f32_16x16x32_bf16 v[12:15], v[72:75], v[120:123], v[12:15]
  ds_read_b128 v[52:55], v7 offset:1024
  v_mfma_f32_16x16x32_bf16 v[32:35], v[72:75], v[124:127], v[32:35]
  ds_read_b128 v[56:59], v7 offset:2048
  v_mfma_f32_16x16x32_bf16 v[16:19], v[76:79], v[120:123], v[16:19]
  ds_read_b128 v[60:63], v7 offset:3072
  v_mfma_f32_16x16x32_bf16 v[36:39], v[76:79], v[124:127], v[36:39]
  ds_read_b128 v[64:67], v7 offset:4096
  v_mfma_f32_16x16x32_bf16 v[20:23], v[80:83], v[120:123], v[20:23]
  v_mfma_f32_16x16x32_bf16 v[40:43], v[80:83], v[124:127], v[40:43]
  v_mfma_f32_16x16x32_bf16 v[24:27], v[84:87], v[120:123], v[24:27]
  v_mfma_f32_16x16x32_bf16 v[44:47], v[84:87], v[124:127], v[44:47]
  s_waitcnt vmcnt(2) lgkmcnt(0)
  v_mfma_f32_16x16x32_bf16 v[8:11], v[48:51], v[88:91], v[8:11]
  v_add_u32 v7, 46080, v6
  v_mfma_f32_16x16x32_bf16 v[28:31], v[48:51], v[92:95], v[28:31]
  ds_read_b128 v[68:71], v7 offset:0
  v_mfma_f32_16x16x32_bf16 v[12:15], v[52:55], v[88:91], v[12:15]
  ds_read_b128 v[72:75], v7 offset:1024
  v_mfma_f32_16x16x32_bf16 v[32:35], v[52:55], v[92:95], v[32:35]
  ds_read_b128 v[76:79], v7 offset:2048
  v_mfma_f32_16x16x32_bf16 v[16:19], v[56:59], v[88:91], v[16:19]
  ds_read_b128 v[80:83], v7 offset:3072
  v_mfma_f32_16x16x32_bf16 v[36:39], v[56:59], v[92:95], v[36:39]
  ds_read_b128 v[84:87], v7 offset:4096
  v_mfma_f32_16x16x32_bf16 v[20:23], v[60:63], v[88:91], v[20:23]
  v_mfma_f32_16x16x32_bf16 v[40:43], v[60:63], v[92:95], v[40:43]
  v_mfma_f32_16x16x32_bf16 v[24:27], v[64:67], v[88:91], v[24:27]
  v_mfma_f32_16x16x32_bf16 v[44:47], v[64:67], v[92:95], v[44:47]
  s_waitcnt lgkmcnt(0)
  s_waitcnt vmcnt(0)
  v_cmp_ne_u32 vcc, s11, v152
  s_cbranch_vccz L_pp_44
  s_mov_b32 s64, 0
  s_waitcnt vmcnt(0)
  global_load_dword v7, v161, s[36:37] sc1
  s_sleep 4
  global_load_dword v152, v161, s[36:37] sc1
L_poll_45:
  s_waitcnt vmcnt(1)
  v_cmp_ne_u32 vcc, s11, v7
  s_cbranch_vccz L_polld_46
  s_sleep 6
  global_load_dword v7, v161, s[36:37] sc1
  s_waitcnt vmcnt(1)
  v_cmp_ne_u32 vcc, s11, v152
  s_cbranch_vccz L_polld_46
  s_sleep 6
  global_load_dword v152, v161, s[36:37] sc1
  s_add_u32 s64, s64, 1
  s_cmp_gt_u32 s64, 200000
  s_cbranch_scc0 L_poll_45
L_polld_46:
  s_waitcnt vmcnt(0)
L_pp_44:
  s_barrier
  s_waitcnt vmcnt(0)
  v_mfma_f32_16x16x32_bf16 v[8:11], v[68:71], v[96:99], v[8:11]
  v_add_u32 v7, 81920, v6
  v_mfma_f32_16x16x32_bf16 v[28:31], v[68:71], v[100:103], v[28:31]
  ds_read_b128 v[48:51], v7 offset:0
  v_mfma_f32_16x16x32_bf16 v[12:15], v[72:75], v[96:99], v[12:15]
  ds_read_b128 v[52:55], v7 offset:1024
  v_mfma_f32_16x16x32_bf16 v[32:35], v[72:75], v[100:103], v[32:35]
  ds_read_b128 v[56:59], v7 offset:2048
  v_mfma_f32_16x16x32_bf16 v[16:19], v[76:79], v[96:99], v[16:19]
  ds_read_b128 v[60:63], v7 offset:3072
  v_mfma_f32_16x16x32_bf16 v[36:39], v[76:79], v[100:103], v[36:39]
  ds_read_b128 v[64:67], v7 offset:4096
  v_mfma_f32_16x16x32_bf16 v[20:23], v[80:83], v[96:99], v[20:23]
  v_mfma_f32_16x16x32_bf16 v[40:43], v[80:83], v[100:103], v[40:43]
  v_mfma_f32_16x16x32_bf16 v[24:27], v[84:87], v[96:99], v[24:27]
  v_mfma_f32_16x16x32_bf16 v[44:47], v[84:87], v[100:103], v[44:47]
  s_add_u32 s60, s87, 0
  buffer_load_dwordx4 v[104:107], v150, s[44:47], s60 offen sc1
  buffer_load_dwordx4 v[108:111], v151, s[44:47], s60 offen sc1
  s_add_u32 s60, s87, 1024
  buffer_load_dwordx4 v[112:115], v150, s[44:47], s60 offen sc1
  buffer_load_dwordx4 v[116:119], v151, s[44:47], s60 offen sc1
  s_add_u32 s60, s87, 2048
  buffer_load_dwordx4 v[120:123], v150, s[44:47], s60 offen sc1
  buffer_load_dwordx4 v[124:127], v151, s[44:47], s60 offen sc1
  s_add_u32 s60, s87, 3072
  buffer_load_dwordx4 v[88:91], v150, s[44:47], s60 offen sc1
  buffer_load_dwordx4 v[92:95], v151, s[44:47], s60 offen sc1
  s_add_u32 s60, s87, 4096
  buffer_load_dwordx4 v[96:99], v150, s[44:47], s60 offen sc1
  buffer_load_dwordx4 v[100:103], v151, s[44:47], s60 offen sc1
  s_waitcnt vmcnt(8) lgkmcnt(0)
  v_mfma_f32_16x16x32_bf16 v[8:11], v[48:51], v[104:107], v[8:11]
  v_add_u32 v7, 87040, v6
  v_mfma_f32_16x16x32_bf16 v[28:31], v[48:51], v[108:111], v[28:31]
  ds_read_b128 v[68:71], v7 offset:0
  v_mfma_f32_16x16x32_bf16 v[12:15], v[52:55], v[104:107], v[12:15]
  ds_read_b128 v[72:75], v7 offset:1024
  v_mfma_f32_16x16x32_bf16 v[32:35], v[52:55], v[108:111], v[32:35]
  ds_read_b128 v[76:79], v7 offset:2048
  v_mfma_f32_16x16x32_bf16 v[16:19], v[56:59], v[104:107], v[16:19]
  ds_read_b128 v[80:83], v7 offset:3072
  v_mfma_f32_16x16x32_bf16 v[36:39], v[56:59], v[108:111], v[36:39]
  ds_read_b128 v[84:87], v7 offset:4096
  v_mfma_f32_16x16x32_bf16 v[20:23], v[60:63], v[104:107], v[20:23]
  v_mfma_f32_16x16x32_bf16 v[40:43], v[60:63], v[108:111], v[40:43]
  v_mfma_f32_16x16x32_bf16 v[24:27], v[64:67], v[104:107], v[24:27]
  v_mfma_f32_16x16x32_bf16 v[44:47], v[64:67], v[108:111], v[44:47]
  buffer_load_dwordx2 v[144:145], v4, s[52:55], s96 offen
  buffer_load_dwordx2 v[146:147], v4, s[52:55], s97 offen
  buffer_load_dwordx2 v[148:149], v4, s[52:55], s98 offen
  s_waitcnt lgkmcnt(0)
  s_waitcnt vmcnt(6)
  v_mfma_f32_16x16x32_bf16 v[8:11], v[68:71], v[112:115], v[8:11]
  v_add_u32 v7, 122880, v6
  v_mfma_f32_16x16x32_bf16 v[28:31], v[68:71], v[116:119], v[28:31]
  ds_read_b128 v[48:51], v7 offset:0
  v_mfma_f32_16x16x32_bf16 v[12:15], v[72:75], v[112:115], v[12:15]
  ds_read_b128 v[52:55], v7 offset:1024
  v_mfma_f32_16x16x32_bf16 v[32:35], v[72:75], v[116:119], v[32:35]
  ds_read_b128 v[56:59], v7 offset:2048
  v_mfma_f32_16x16x32_bf16 v[16:19], v[76:79], v[112:115], v[16:19]
  ds_read_b128 v[60:63], v7 offset:3072
  v_mfma_f32_16x16x32_bf16 v[36:39], v[76:79], v[116:119], v[36:39]
  ds_read_b128 v[64:67], v7 offset:4096
  v_mfma_f32_16x16x32_bf16 v[20:23], v[80:83], v[112:115], v[20:23]
  v_mfma_f32_16x16x32_bf16 v[40:43], v[80:83], v[116:119], v[40:43]
  v_mfma_f32_16x16x32_bf16 v[24:27], v[84:87], v[112:115], v[24:27]
  v_mfma_f32_16x16x32_bf16 v[44:47], v[84:87], v[116:119], v[44:47]
  s_waitcnt vmcnt(4) lgkmcnt(0)
  v_mfma_f32_16x16x32_bf16 v[8:11], v[48:51], v[120:123], v[8:11]
  v_add_u32 v7, 128000, v6
  v_mfma_f32_16x16x32_bf16 v[28:31], v[48:51], v[124:127], v[28:31]
  ds_read_b128 v[68:71], v7 offset:0
  v_mfma_f32_16x16x32_bf16 v[12:15], v[52:55], v[120:123], v[12:15]
  ds_read_b128 v[72:75], v7 offset:1024
  v_mfma_f32_16x16x32_bf16 v[32:35], v[52:55], v[124:127], v[32:35]
  ds_read_b128 v[76:79], v7 offset:2048
  v_mfma_f32_16x16x32_bf16 v[16:19], v[56:59], v[120:123], v[16:19]
  ds_read_b128 v[80:83], v7 offset:3072
  v_mfma_f32_16x16x32_bf16 v[36:39], v[56:59], v[124:127], v[36:39]
  ds_read_b128 v[84:87], v7 offset:4096
  v_mfma_f32_16x16x32_bf16 v[20:23], v[60:63], v[120:123], v[20:23]
  v_mfma_f32_16x16x32_bf16 v[40:43], v[60:63], v[124:127], v[40:43]
  v_mfma_f32_16x16x32_bf16 v[24:27], v[64:67], v[120:123], v[24:27]
  v_mfma_f32_16x16x32_bf16 v[44:47], v[64:67], v[124:127], v[44:47]
  s_waitcnt lgkmcnt(0)
  s_barrier
  s_waitcnt vmcnt(2)
  v_mfma_f32_16x16x32_bf16 v[8:11], v[68:71], v[88:91], v[8:11]
  v_add_u32 v7, 0, v6
  v_mfma_f32_16x16x32_bf16 v[28:31], v[68:71], v[92:95], v[28:31]
  ds_read_b128 v[48:51], v7 offset:0
  v_mfma_f32_16x16x32_bf16 v[12:15], v[72:75], v[88:91], v[12:15]
  ds_read_b128 v[52:55], v7 offset:1024
  v_mfma_f32_16x16x32_bf16 v[32:35], v[72:75], v[92:95], v[32:35]
  ds_read_b128 v[56:59], v7 offset:2048
  v_mfma_f32_16x16x32_bf16 v[16:19], v[76:79], v[88:91], v[16:19]
  ds_read_b128 v[60:63], v7 offset:3072
  v_mfma_f32_16x16x32_bf16 v[36:39], v[76:79], v[92:95], v[36:39]
  ds_read_b128 v[64:67], v7 offset:4096
  v_mfma_f32_16x16x32_bf16 v[20:23], v[80:83], v[88:91], v[20:23]
  v_mfma_f32_16x16x32_bf16 v[40:43], v[80:83], v[92:95], v[40:43]
  v_mfma_f32_16x16x32_bf16 v[24:27], v[84:87], v[88:91], v[24:27]
  v_mfma_f32_16x16x32_bf16 v[44:47], v[84:87], v[92:95], v[44:47]
  s_waitcnt vmcnt(0) lgkmcnt(0)
  v_mfma_f32_16x16x32_bf16 v[8:11], v[48:51], v[96:99], v[8:11]
  v_mfma_f32_16x16x32_bf16 v[28:31], v[48:51], v[100:103], v[28:31]
  v_mfma_f32_16x16x32_bf16 v[12:15], v[52:55], v[96:99], v[12:15]
  v_mfma_f32_16x16x32_bf16 v[32:35], v[52:55], v[100:103], v[32:35]
  v_mfma_f32_16x16x32_bf16 v[16:19], v[56:59], v[96:99], v[16:19]
  v_mfma_f32_16x16x32_bf16 v[36:39], v[56:59], v[100:103], v[36:39]
  v_mfma_f32_16x16x32_bf16 v[20:23], v[60:63], v[96:99], v[20:23]
  v_mfma_f32_16x16x32_bf16 v[40:43], v[60:63], v[100:103], v[40:43]
  v_mfma_f32_16x16x32_bf16 v[24:27], v[64:67], v[96:99], v[24:27]
  v_mfma_f32_16x16x32_bf16 v[44:47], v[64:67], v[100:103], v[44:47]
  s_mul_i32 s12, s9, 40960
  s_mul_i32 s13, s10, 10240
  s_add_u32 s12, s12, s13
  s_add_u32 s12, s12, 40960
  v_lshl_add_u32 v6, v0, 4, s12
  ds_write_b128 v6, v[8:11] offset:0
  ds_write_b128 v6, v[12:15] offset:1024
  ds_write_b128 v6, v[16:19] offset:2048
  ds_write_b128 v6, v[20:23] offset:3072
  ds_write_b128 v6, v[24:27] offset:4096
  ds_write_b128 v6, v[28:31] offset:5120
  ds_write_b128 v6, v[32:35] offset:6144
  ds_write_b128 v6, v[36:39] offset:7168
  ds_write_b128 v6, v[40:43] offset:8192
  ds_write_b128 v6, v[44:47] offset:9216
  s_mov_b32 s48, s32
  s_mov_b32 s49, s33
  s_mov_b32 s50, 2621440
  s_mov_b32 s51, 0x20000
  s_mul_i32 s12, s9, 40960
  s_lshl_b32 s13, s10, 10
  s_add_u32 s12, s12, s13
  s_add_u32 s12, s12, 40960
  v_lshl_add_u32 v6, v0, 4, s12
  s_waitcnt lgkmcnt(0)
  s_barrier
  ds_read_b128 v[48:51], v6 offset:0
  ds_read_b128 v[52:55], v6 offset:10240
  ds_read_b128 v[56:59], v6 offset:20480
  ds_read_b128 v[60:63], v6 offset:30720
  ds_read_b128 v[64:67], v6 offset:4096
  ds_read_b128 v[68:71], v6 offset:14336
  ds_read_b128 v[72:75], v6 offset:24576
  ds_read_b128 v[76:79], v6 offset:34816
  ds_read_b128 v[80:83], v6 offset:8192
  ds_read_b128 v[84:87], v6 offset:18432
  ds_read_b128 v[88:91], v6 offset:28672
  ds_read_b128 v[92:95], v6 offset:38912
  s_waitcnt lgkmcnt(8)
  v_pk_add_f32 v[48:49], v[48:49], v[52:53]
  v_pk_add_f32 v[56:57], v[56:57], v[60:61]
  v_pk_add_f32 v[50:51], v[50:51], v[54:55]
  v_pk_add_f32 v[58:59], v[58:59], v[62:63]
  v_lshlrev_b32 v52, 16, v144
  v_and_b32 v53, 0xffff0000, v144
  v_lshlrev_b32 v54, 16, v145
  v_and_b32 v55, 0xffff0000, v145
  v_pk_add_f32 v[48:49], v[48:49], v[56:57]
  v_pk_add_f32 v[50:51], v[50:51], v[58:59]
  v_pk_add_f32 v[48:49], v[48:49], v[52:53]
  v_pk_add_f32 v[50:51], v[50:51], v[54:55]
  v_cvt_pk_bf16_f32 v56, v48, v49
  v_cvt_pk_bf16_f32 v57, v50, v51
  buffer_store_dwordx2 v[56:57], v4, s[48:51], s96 offen
  s_waitcnt lgkmcnt(4)
  v_pk_add_f32 v[64:65], v[64:65], v[68:69]
  v_pk_add_f32 v[72:73], v[72:73], v[76:77]
  v_pk_add_f32 v[66:67], v[66:67], v[70:71]
  v_pk_add_f32 v[74:75], v[74:75], v[78:79]
  v_lshlrev_b32 v68, 16, v146
  v_and_b32 v69, 0xffff0000, v146
  v_lshlrev_b32 v70, 16, v147
  v_and_b32 v71, 0xffff0000, v147
  v_pk_add_f32 v[64:65], v[64:65], v[72:73]
  v_pk_add_f32 v[66:67], v[66:67], v[74:75]
  v_pk_add_f32 v[64:65], v[64:65], v[68:69]
  v_pk_add_f32 v[66:67], v[66:67], v[70:71]
  v_cvt_pk_bf16_f32 v72, v64, v65
  v_cvt_pk_bf16_f32 v73, v66, v67
  buffer_store_dwordx2 v[72:73], v4, s[48:51], s97 offen
  s_cmp_ge_u32 s10, 2
  s_cbranch_scc1 L_fin_49
  s_waitcnt lgkmcnt(0)
  v_pk_add_f32 v[80:81], v[80:81], v[84:85]
  v_pk_add_f32 v[88:89], v[88:89], v[92:93]
  v_pk_add_f32 v[82:83], v[82:83], v[86:87]
  v_pk_add_f32 v[90:91], v[90:91], v[94:95]
  v_lshlrev_b32 v84, 16, v148
  v_and_b32 v85, 0xffff0000, v148
  v_lshlrev_b32 v86, 16, v149
  v_and_b32 v87, 0xffff0000, v149
  v_pk_add_f32 v[80:81], v[80:81], v[88:89]
  v_pk_add_f32 v[82:83], v[82:83], v[90:91]
  v_pk_add_f32 v[80:81], v[80:81], v[84:85]
  v_pk_add_f32 v[82:83], v[82:83], v[86:87]
  v_cvt_pk_bf16_f32 v88, v80, v81
  v_cvt_pk_bf16_f32 v89, v82, v83
  buffer_store_dwordx2 v[88:89], v4, s[48:51], s98 offen
L_fin_49:
  s_endpgm
L_att:
  s_mov_b32 s44, s16
  s_mov_b32 s45, s17
  s_mov_b32 s46, 2621440
  s_mov_b32 s47, 0x20000
  s_lshl_b32 s12, s4, 3
  s_add_u32 s12, s12, s5
  s_lshl_b32 s12, s12, 4
  s_lshl_b32 s13, s3, 1
  s_add_u32 s12, s12, s13
  s_mul_i32 s12, s12, 1280
  s_add_u32 s13, s12, 1280
  v_lshlrev_b32 v1, 4, v0
  v_add_u32 v2, 1024, v1
  v_mov_b32 v3, 0x40000000
  v_cmp_gt_u32 vcc, 16, v0
  s_nop 1
  v_cndmask_b32 v2, v3, v2, vcc
  buffer_load_dwordx4 v[104:107], v1, s[44:47], s12 offen
  buffer_load_dwordx4 v[108:111], v2, s[44:47], s12 offen
  buffer_load_dwordx4 v[112:115], v1, s[44:47], s13 offen
  buffer_load_dwordx4 v[116:119], v2, s[44:47], s13 offen
  s_mov_b32 s44, s20
  s_mov_b32 s45, s21
  s_mov_b32 s46, 25600
  s_mov_b32 s47, 0x20000
  s_lshl_b32 s12, s5, 2
  s_add_u32 s12, s12, s10
  s_mul_i32 s12, s12, 800
  v_min_u32 v1, 49, v0
  v_lshlrev_b32 v1, 4, v1
  buffer_load_dwordx4 v[150:153], v1, s[44:47], s12 offen
  v_and_b32 v1, 31, v0
  s_lshl_b32 s12, s9, 6
  v_add_u32 v1, s12, v1
  v_lshlrev_b32 v1, 7, v1
  v_bfe_u32 v2, v0, 1, 3
  v_lshrrev_b32 v3, 5, v0
  v_add_u32 v4, 0, v3
  v_xor_b32 v4, v4, v2
  v_lshl_add_u32 v144, v4, 4, v1
  v_add_u32 v4, 2, v3
  v_xor_b32 v4, v4, v2
  v_lshl_add_u32 v145, v4, 4, v1
  v_add_u32 v4, 4, v3
  v_xor_b32 v4, v4, v2
  v_lshl_add_u32 v146, v4, 4, v1
  v_add_u32 v4, 6, v3
  v_xor_b32 v4, v4, v2
  v_lshl_add_u32 v147, v4, 4, v1
  v_bfe_u32 v2, v0, 4, 1
  v_and_b32 v3, 3, v0
  v_lshl_add_u32 v2, v2, 2, v3
  v_bfe_u32 v3, v0, 2, 2
  v_lshrrev_b32 v4, 5, v0
  v_lshl_add_u32 v4, v4, 3, v3
  v_lshlrev_b32 v4, 9, v4
  s_mul_i32 s12, s10, 5
  v_add_u32 v5, 40, v2
  v_cmp_gt_u32 vcc, 5, v2
  s_nop 1
  v_cndmask_b32 v5, v5, v2, vcc
  v_cmp_eq_u32 vcc, 7, v2
  s_nop 1
  v_cndmask_b32 v5, v5, 7, vcc
  v_add_u32 v5, s12, v5
  v_lshrrev_b32 v6, 1, v5
  v_lshlrev_b32 v7, 2, v3
  v_xor_b32 v6, v6, v7
  v_lshl_add_u32 v6, v6, 4, v4
  v_and_b32 v5, 1, v5
  v_lshl_add_u32 v6, v5, 3, v6
  v_add_u32 v148, 49152, v6
  v_add_u32 v5, 37, v2
  v_add_u32 v6, 22, v2
  v_cmp_gt_u32 vcc, 5, v2
  s_nop 1
  v_cndmask_b32 v5, v5, v6, vcc
  v_add_u32 v5, s12, v5
  v_lshrrev_b32 v6, 1, v5
  v_lshlrev_b32 v7, 2, v3
  v_xor_b32 v6, v6, v7
  v_lshl_add_u32 v6, v6, 4, v4
  v_and_b32 v5, 1, v5
  v_lshl_add_u32 v6, v5, 3, v6
  v_add_u32 v149, 49152, v6
  s_mov_b32 s70, -1
  s_mov_b32 s71, 0
  s_mov_b32 s72, 0
  s_mov_b32 s73, -1
  v_mov_b32 v48, 0
  v_mov_b32 v49, 0
  v_mov_b32 v50, 0
  v_mov_b32 v51, 0
  v_mov_b32 v52, 0
  v_mov_b32 v53, 0
  v_mov_b32 v54, 0
  v_mov_b32 v55, 0
  v_mov_b32 v56, 0
  v_mov_b32 v57, 0
  v_mov_b32 v58, 0
  v_mov_b32 v59, 0
  v_mov_b32 v60, 0
  v_mov_b32 v61, 0
  v_mov_b32 v62, 0
  v_mov_b32 v63, 0
  v_mov_b32 v64, 0
  v_mov_b32 v65, 0
  v_mov_b32 v66, 0
  v_mov_b32 v67, 0
  v_mov_b32 v68, 0
  v_mov_b32 v69, 0
  v_mov_b32 v70, 0
  v_mov_b32 v71, 0
  s_waitcnt vmcnt(0)
  s_mul_i32 s12, s10, 800
  s_add_u32 s12, s12, 155904
  v_min_u32 v1, 49, v0
  v_lshl_add_u32 v1, v1, 4, s12
  ds_write_b128 v1, v[150:153]
  s_mov_b32 s67, 0x00003f80
  s_mov_b32 s68, 0x3f800000
  v_mov_b32 v8, 0
  v_mov_b32 v9, 0
  v_mov_b32 v10, 0
  v_mov_b32 v11, 0
  v_dot2c_f32_bf16 v8, s59, v104
  v_dot2c_f32_bf16 v9, v104, v104
  v_dot2c_f32_bf16 v8, s59, v105
  v_dot2c_f32_bf16 v9, v105, v105
  v_dot2c_f32_bf16 v8, s59, v106
  v_dot2c_f32_bf16 v9, v106, v106
  v_dot2c_f32_bf16 v8, s59, v107
  v_dot2c_f32_bf16 v9, v107, v107
  v_dot2c_f32_bf16 v8, s59, v108
  v_dot2c_f32_bf16 v9, v108, v108
  v_dot2c_f32_bf16 v8, s59, v109
  v_dot2c_f32_bf16 v9, v109, v109
  v_dot2c_f32_bf16 v8, s59, v110
  v_dot2c_f32_bf16 v9, v110, v110
  v_dot2c_f32_bf16 v8, s59, v111
  v_dot2c_f32_bf16 v9, v111, v111
  v_dot2c_f32_bf16 v10, s59, v112
  v_dot2c_f32_bf16 v11, v112, v112
  v_dot2c_f32_bf16 v10, s59, v113
  v_dot2c_f32_bf16 v11, v113, v113
  v_dot2c_f32_bf16 v10, s59, v114
  v_dot2c_f32_bf16 v11, v114, v114
  v_dot2c_f32_bf16 v10, s59, v115
  v_dot2c_f32_bf16 v11, v115, v115
  v_dot2c_f32_bf16 v10, s59, v116
  v_dot2c_f32_bf16 v11, v116, v116
  v_dot2c_f32_bf16 v10, s59, v117
  v_dot2c_f32_bf16 v11, v117, v117
  v_dot2c_f32_bf16 v10, s59, v118
  v_dot2c_f32_bf16 v11, v118, v118
  v_dot2c_f32_bf16 v10, s59, v119
  v_dot2c_f32_bf16 v11, v119, v119
  v_add_f32_dpp v8, v8, v8 row_ror:8 row_mask:0xf bank_mask:0xf
  v_add_f32_dpp v9, v9, v9 row_ror:8 row_mask:0xf bank_mask:0xf
  v_add_f32_dpp v10, v10, v10 row_ror:8 row_mask:0xf bank_mask:0xf
  v_add_f32_dpp v11, v11, v11 row_ror:8 row_mask:0xf bank_mask:0xf
  v_add_f32_dpp v8, v8, v8 row_ror:4 row_mask:0xf bank_mask:0xf
  v_add_f32_dpp v9, v9, v9 row_ror:4 row_mask:0xf bank_mask:0xf
  v_add_f32_dpp v10, v10, v10 row_ror:4 row_mask:0xf bank_mask:0xf
  v_add_f32_dpp v11, v11, v11 row_ror:4 row_mask:0xf bank_mask:0xf
  v_add_f32_dpp v8, v8, v8 row_ror:2 row_mask:0xf bank_mask:0xf
  v_add_f32_dpp v9, v9, v9 row_ror:2 row_mask:0xf bank_mask:0xf
  v_add_f32_dpp v10, v10, v10 row_ror:2 row_mask:0xf bank_mask:0xf
  v_add_f32_dpp v11, v11, v11 row_ror:2 row_mask:0xf bank_mask:0xf
  v_add_f32_dpp v8, v8, v8 row_ror:1 row_mask:0xf bank_mask:0xf
  v_add_f32_dpp v9, v9, v9 row_ror:1 row_mask:0xf bank_mask:0xf
  v_add_f32_dpp v10, v10, v10 row_ror:1 row_mask:0xf bank_mask:0xf
  v_add_f32_dpp v11, v11, v11 row_ror:1 row_mask:0xf bank_mask:0xf
  v_mov_b32 v12, v8
  v_mov_b32 v13, v9
  v_mov_b32 v14, v10
  v_mov_b32 v15, v11
  v_permlane16_swap_b32 v8, v12
  v_permlane16_swap_b32 v9, v13
  v_permlane16_swap_b32 v10, v14
  v_permlane16_swap_b32 v11, v15
  v_add_f32 v8, v8, v12
  v_add_f32 v9, v9, v13
  v_add_f32 v10, v10, v14
  v_add_f32 v11, v11, v15
  v_mov_b32 v12, v8
  v_mov_b32 v13, v9
  v_mov_b32 v14, v10
  v_mov_b32 v15, v11
  v_permlane32_swap_b32 v8, v12
  v_permlane32_swap_b32 v9, v13
  v_permlane32_swap_b32 v10, v14
  v_permlane32_swap_b32 v11, v15
  v_add_f32 v8, v8, v12
  v_add_f32 v9, v9, v13
  v_add_f32 v10, v10, v14
  v_add_f32 v11, v11, v15
  s_lshl_b32 s12, s4, 3
  s_add_u32 s12, s12, s5
  s_lshl_b32 s12, s12, 4
  s_lshl_b32 s13, s3, 1
  s_add_u32 s12, s12, s13
  s_lshl_b32 s12, s12, 3
  s_add_u32 s12, s12, 98304
  v_mov_b32 v12, s12
  s_mov_b64 exec, 1
  global_store_dwordx4 v12, v[8:11], s[36:37] sc1
  s_mov_b64 exec, -1
  s_waitcnt lgkmcnt(0)
  v_and_b32 v1, 31, v0
  v_subrev_u32 v2, 4, v1
  v_cmp_le_u32 vcc, 20, v1
  s_nop 1
  v_cndmask_b32 v2, v1, v2, vcc
  v_cmp_le_u32 vcc, 24, v1
  s_nop 1
  v_cndmask_b32 v2, v2, 0, vcc
  v_lshlrev_b32 v2, 1, v2
  v_lshrrev_b32 v3, 5, v0
  v_mul_u32_u24 v3, 160, v3
  v_add_u32 v2, v2, v3
  s_mul_i32 s12, s10, 800
  s_add_u32 s12, s12, 155904
  v_add_u32 v2, s12, v2
  ds_read_u16 v150, v2 offset:0
  ds_read_u16 v151, v2 offset:40
  ds_read_u16 v152, v2 offset:80
  ds_read_u16 v153, v2 offset:120
  ds_read_u16 v154, v2 offset:320
  ds_read_u16 v155, v2 offset:360
  ds_read_u16 v156, v2 offset:400
  ds_read_u16 v157, v2 offset:440
  ds_read_u16 v158, v2 offset:640
  ds_read_u16 v159, v2 offset:680
  ds_read_u16 v160, v2 offset:720
  ds_read_u16 v161, v2 offset:760
  s_waitcnt lgkmcnt(0)
  v_lshl_or_b32 v72, v151, 16, v150
  v_lshl_or_b32 v73, v153, 16, v152
  v_lshl_or_b32 v74, v155, 16, v154
  v_lshl_or_b32 v75, v157, 16, v156
  v_lshl_or_b32 v76, v159, 16, v158
  v_lshl_or_b32 v77, v161, 16, v160
  v_cmp_gt_u32 vcc, 32, v0
  s_nop 1
  v_cndmask_b32 v76, 0, v76, vcc
  v_cndmask_b32 v77, 0, v77, vcc
  v_mov_b32 v78, 0
  v_mov_b32 v79, 0
  v_cndmask_b32 v80, 0, 1.0, vcc
  v_mov_b32 v81, s59
  v_mov_b32 v8, 0
  v_mov_b32 v9, 0
  v_mov_b32 v10, 0
  v_mov_b32 v11, 0
  v_mov_b32 v12, 0
  v_mov_b32 v13, 0
  v_mov_b32 v14, 0
  v_mov_b32 v15, 0
  v_mov_b32 v16, 0
  v_mov_b32 v17, 0
  v_mov_b32 v18, 0
  v_mov_b32 v19, 0
  v_mov_b32 v20, 0
  v_mov_b32 v21, 0
  v_mov_b32 v22, 0
  v_mov_b32 v23, 0
  v_mov_b32 v24, 0
  v_mov_b32 v25, 0
  v_mov_b32 v26, 0
  v_mov_b32 v27, 0
  v_mov_b32 v28, 0
  v_mov_b32 v29, 0
  v_mov_b32 v30, 0
  v_mov_b32 v31, 0
  v_mov_b32 v32, 0
  v_mov_b32 v33, 0
  v_mov_b32 v34, 0
  v_mov_b32 v35, 0
  v_mov_b32 v36, 0
  v_mov_b32 v37, 0
  v_mov_b32 v38, 0
  v_mov_b32 v39, 0
  v_mov_b32 v40, 0
  v_mov_b32 v41, 0
  v_mov_b32 v42, 0
  v_mov_b32 v43, 0
  v_mov_b32 v44, 0
  v_mov_b32 v45, 0
  v_mov_b32 v46, 0
  v_mov_b32 v47, 0
  s_waitcnt lgkmcnt(0)
  s_mov_b32 s56, 0
  s_mov_b32 s57, 0
  s_mov_b32 s58, 0
  s_mov_b32 s80, 16384
  s_mov_b32 s81, 16384
  s_barrier
  v_mov_b32 v1, 0
  global_load_dword v166, v1, s[34:35] sc1
  ds_read_b128 v[104:107], v144
  ds_read_b128 v[108:111], v144 offset:4096
  ds_read_b64_tr_b16 v[112:113], v148 offset:0
  ds_read_b64_tr_b16 v[114:115], v148 offset:2048
  ds_read_b64_tr_b16 v[116:117], v149 offset:0
  ds_read_b64_tr_b16 v[118:119], v149 offset:2048
L_main_51:
  s_waitcnt lgkmcnt(0)
  v_mfma_f32_32x32x16_bf16 v[8:23], v[112:115], v[104:107], v[8:23]
  ds_read_b128 v[120:123], v145
  ds_read_b128 v[124:127], v145 offset:4096
  ds_read_b64_tr_b16 v[128:129], v148 offset:8192
  v_mfma_f32_32x32x16_bf16 v[40:55], v[112:115], v[108:111], v[40:55]
  ds_read_b64_tr_b16 v[130:131], v148 offset:10240
  ds_read_b64_tr_b16 v[132:133], v149 offset:8192
  ds_read_b64_tr_b16 v[134:135], v149 offset:10240
  v_mfma_f32_32x32x16_bf16 v[24:39], v[116:119], v[104:107], v[24:39]
  v_mfma_f32_32x32x16_bf16 v[56:71], v[116:119], v[108:111], v[56:71]
  s_cmp_eq_u32 s56, 1
  s_cbranch_scc0 L_vw_52
  s_waitcnt vmcnt(0)
L_vw_52:
  s_waitcnt lgkmcnt(0)
  s_barrier
  s_cmp_eq_u32 s56, 1
  s_cbranch_scc0 L_wf_53
  v_readfirstlane_b32 s11, v166
  s_nop 0
  s_cmp_eq_u32 s11, 0
  s_cbranch_scc0 L_tg_54
  v_mov_b32 v2, 0
  s_mov_b32 s64, 0
L_tag_55:
  global_load_dword v1, v2, s[34:35] sc1
  s_waitcnt vmcnt(0)
  v_readfirstlane_b32 s11, v1
  s_add_u32 s64, s64, 1
  s_cmp_gt_u32 s64, 200000
  s_cbranch_scc1 L_tagd_56
  s_cmp_eq_u32 s11, 0
  s_cbranch_scc0 L_tagd_56
  s_sleep 1
  s_branch L_tag_55
L_tagd_56:
L_tg_54:
  s_cmp_eq_u32 s3, 0
  s_cbranch_scc0 L_sf_57
  s_lshl_b32 s12, s4, 3
  s_add_u32 s12, s12, s5
  s_lshl_b32 s12, s12, 7
  s_add_u32 s12, s12, 81920
  v_mov_b32 v1, s12
  v_mov_b32 v2, s11
  s_mov_b64 s[62:63], exec
  s_mov_b64 exec, 1
  global_store_dword v1, v2, s[36:37] sc1
  s_mov_b64 exec, s[62:63]
L_sf_57:
L_wf_53:
  s_waitcnt lgkmcnt(0)
  v_mfma_f32_32x32x16_bf16 v[8:23], v[128:131], v[120:123], v[8:23]
  s_add_u32 s57, s57, 1
  s_cmp_eq_u32 s57, 6
  s_cselect_b32 s65, 4294885376, s80
  s_cselect_b32 s57, 0, s57
  v_add_u32 v148, s65, v148
  v_add_u32 v149, s65, v149
  ds_read_b128 v[104:107], v146
  ds_read_b128 v[108:111], v146 offset:4096
  ds_read_b64_tr_b16 v[112:113], v148 offset:0
  v_mfma_f32_32x32x16_bf16 v[40:55], v[128:131], v[124:127], v[40:55]
  ds_read_b64_tr_b16 v[114:115], v148 offset:2048
  ds_read_b64_tr_b16 v[116:117], v149 offset:0
  ds_read_b64_tr_b16 v[118:119], v149 offset:2048
  v_mfma_f32_32x32x16_bf16 v[24:39], v[132:135], v[120:123], v[24:39]
  v_mfma_f32_32x32x16_bf16 v[56:71], v[132:135], v[124:127], v[56:71]
  s_waitcnt lgkmcnt(0)
  v_mfma_f32_32x32x16_bf16 v[8:23], v[112:115], v[104:107], v[8:23]
  ds_read_b128 v[120:123], v147
  ds_read_b128 v[124:127], v147 offset:4096
  ds_read_b64_tr_b16 v[128:129], v148 offset:8192
  v_mfma_f32_32x32x16_bf16 v[40:55], v[112:115], v[108:111], v[40:55]
  ds_read_b64_tr_b16 v[130:131], v148 offset:10240
  ds_read_b64_tr_b16 v[132:133], v149 offset:8192
  ds_read_b64_tr_b16 v[134:135], v149 offset:10240
  v_mfma_f32_32x32x16_bf16 v[24:39], v[116:119], v[104:107], v[24:39]
  v_mfma_f32_32x32x16_bf16 v[56:71], v[116:119], v[108:111], v[56:71]
  s_waitcnt lgkmcnt(0)
  s_barrier
  s_waitcnt lgkmcnt(0)
  v_mfma_f32_32x32x16_bf16 v[8:23], v[128:131], v[120:123], v[8:23]
  s_add_u32 s57, s57, 1
  s_cmp_eq_u32 s57, 6
  s_cselect_b32 s65, 4294885376, s80
  s_cselect_b32 s57, 0, s57
  v_add_u32 v148, s65, v148
  v_add_u32 v149, s65, v149
  s_add_u32 s58, s58, 1
  s_cmp_eq_u32 s58, 3
  s_cselect_b32 s66, 4294934528, s81
  s_cselect_b32 s58, 0, s58
  v_add_u32 v144, s66, v144
  ds_read_b128 v[104:107], v144
  ds_read_b128 v[108:111], v144 offset:4096
  ds_read_b64_tr_b16 v[112:113], v148 offset:0
  v_mfma_f32_32x32x16_bf16 v[40:55], v[128:131], v[124:127], v[40:55]
  ds_read_b64_tr_b16 v[114:115], v148 offset:2048
  ds_read_b64_tr_b16 v[116:117], v149 offset:0
  ds_read_b64_tr_b16 v[118:119], v149 offset:2048
  v_mfma_f32_32x32x16_bf16 v[24:39], v[132:135], v[120:123], v[24:39]
  v_add_u32 v145, s66, v145
  v_add_u32 v146, s66, v146
  v_add_u32 v147, s66, v147
  v_mfma_f32_32x32x16_bf16 v[56:71], v[132:135], v[124:127], v[56:71]
  s_add_u32 s56, s56, 1
  s_cmp_lt_u32 s56, 10
  s_cbranch_scc1 L_main_51
  v_and_b32 v1, 31, v0
  s_lshl_b32 s13, s9, 6
  v_add_u32 v1, s13, v1
  v_lshlrev_b32 v1, 3, v1
  v_add_u32 v1, 147712, v1
  ds_read_b64 v[2:3], v1
  ds_read_b64 v[4:5], v1 offset:256
  s_mul_i32 s12, s10, 256
  s_add_u32 s12, s12, 148736
  v_lshrrev_b32 v6, 5, v0
  v_lshl_add_u32 v6, v6, 4, s12
  ds_read_b128 v[104:107], v6 offset:0
  ds_read_b128 v[108:111], v6 offset:32
  ds_read_b128 v[112:115], v6 offset:64
  ds_read_b128 v[116:119], v6 offset:96
  ds_read_b128 v[120:123], v6 offset:128
  ds_read_b128 v[124:127], v6 offset:160
  ds_read_b128 v[128:131], v6 offset:192
  ds_read_b128 v[132:135], v6 offset:224
  s_waitcnt lgkmcnt(8)
  s_mov_b32 s12, 0x3acccccd
  v_mul_f32 v2, s12, v2
  v_mul_f32 v3, s12, v3
  v_fma_f32 v3, -v2, v2, v3
  v_max_f32 v3, 0, v3
  v_add_f32 v3, 0x3727c5ac, v3
  v_rsq_f32 v96, v3
  v_sub_f32 v94, 0, v2
  v_mul_f32 v4, s12, v4
  v_mul_f32 v5, s12, v5
  v_fma_f32 v5, -v4, v4, v5
  v_max_f32 v5, 0, v5
  v_add_f32 v5, 0x3727c5ac, v5
  v_rsq_f32 v97, v5
  v_sub_f32 v95, 0, v4
  s_mov_b32 s12, 1069066811
  v_mov_b32 v82, v94
  v_mov_b32 v86, v96
  v_mul_f32 v90, s12, v96
  v_mov_b32 v84, v95
  v_mov_b32 v88, v97
  v_mul_f32 v92, s12, v97
  v_and_b32 v1, 31, v0
  s_lshl_b32 s13, s9, 6
  v_add_u32 v1, s13, v1
  v_mul_u32_u24 v1, 40, v1
  s_mul_i32 s13, s10, 5120
  v_add_u32 v1, s13, v1
  v_add_u32 v162, 122880, v1
  v_add_u32 v163, s13, v1
  v_lshrrev_b32 v2, 5, v0
  v_lshlrev_b32 v2, 3, v2
  v_add_u32 v163, v163, v2
  v_add_u32 v163, 81920, v163
  s_waitcnt lgkmcnt(0)
  v_fmac_f32 v24, v82, v120
  v_fmac_f32 v25, v82, v121
  v_fmac_f32 v26, v82, v122
  v_fmac_f32 v27, v82, v123
  v_fmac_f32 v28, v82, v124
  v_fmac_f32 v29, v82, v125
  v_fmac_f32 v30, v82, v126
  v_fmac_f32 v31, v82, v127
  v_fmac_f32 v32, v82, v128
  v_fmac_f32 v33, v82, v129
  v_fmac_f32 v34, v82, v130
  v_fmac_f32 v35, v82, v131
  v_fmac_f32 v36, v82, v132
  v_fmac_f32 v37, v82, v133
  v_fmac_f32 v38, v82, v134
  v_fmac_f32 v39, v82, v135
  v_fmac_f32 v56, v84, v120
  v_fmac_f32 v57, v84, v121
  v_fmac_f32 v58, v84, v122
  v_fmac_f32 v59, v84, v123
  v_fmac_f32 v60, v84, v124
  v_fmac_f32 v61, v84, v125
  v_fmac_f32 v62, v84, v126
  v_fmac_f32 v63, v84, v127
  v_fmac_f32 v64, v84, v128
  v_fmac_f32 v65, v84, v129
  v_fmac_f32 v66, v84, v130
  v_fmac_f32 v67, v84, v131
  v_fmac_f32 v68, v84, v132
  v_fmac_f32 v69, v84, v133
  v_fmac_f32 v70, v84, v134
  v_fmac_f32 v71, v84, v135
  v_fmac_f32 v8, v82, v104
  v_fmac_f32 v9, v82, v105
  v_fmac_f32 v10, v82, v106
  v_fmac_f32 v11, v82, v107
  v_fmac_f32 v12, v82, v108
  v_fmac_f32 v13, v82, v109
  v_fmac_f32 v14, v82, v110
  v_fmac_f32 v15, v82, v111
  v_fmac_f32 v16, v82, v112
  v_fmac_f32 v17, v82, v113
  v_fmac_f32 v18, v82, v114
  v_fmac_f32 v19, v82, v115
  v_fmac_f32 v20, v82, v116
  v_fmac_f32 v21, v82, v117
  v_fmac_f32 v22, v82, v118
  v_fmac_f32 v23, v82, v119
  v_fmac_f32 v40, v84, v104
  v_fmac_f32 v41, v84, v105
  v_fmac_f32 v42, v84, v106
  v_fmac_f32 v43, v84, v107
  v_fmac_f32 v44, v84, v108
  v_fmac_f32 v45, v84, v109
  v_fmac_f32 v46, v84, v110
  v_fmac_f32 v47, v84, v111
  v_fmac_f32 v48, v84, v112
  v_fmac_f32 v49, v84, v113
  v_fmac_f32 v50, v84, v114
  v_fmac_f32 v51, v84, v115
  v_fmac_f32 v52, v84, v116
  v_fmac_f32 v53, v84, v117
  v_fmac_f32 v54, v84, v118
  v_fmac_f32 v55, v84, v119
  v_cvt_pk_bf16_f32 v24, v24, v25
  v_cvt_pk_bf16_f32 v25, v26, v27
  v_cvt_pk_bf16_f32 v26, v28, v29
  v_cvt_pk_bf16_f32 v27, v30, v31
  v_cvt_pk_bf16_f32 v28, v32, v33
  v_cvt_pk_bf16_f32 v29, v34, v35
  v_cvt_pk_bf16_f32 v30, v36, v37
  v_cvt_pk_bf16_f32 v31, v38, v39
  v_cvt_pk_bf16_f32 v56, v56, v57
  v_cvt_pk_bf16_f32 v57, v58, v59
  v_cvt_pk_bf16_f32 v58, v60, v61
  v_cvt_pk_bf16_f32 v59, v62, v63
  v_cvt_pk_bf16_f32 v60, v64, v65
  v_cvt_pk_bf16_f32 v61, v66, v67
  v_cvt_pk_bf16_f32 v62, v68, v69
  v_cvt_pk_bf16_f32 v63, v70, v71
  v_mfma_f32_32x32x16_bf16 v[104:119], v[72:75], v[24:27], 0
  v_mfma_f32_32x32x16_bf16 v[104:119], v[76:79], v[28:31], v[104:119]
  v_mfma_f32_32x32x16_bf16 v[120:135], v[72:75], v[56:59], 0
  v_mfma_f32_32x32x16_bf16 v[120:135], v[76:79], v[60:63], v[120:135]
  v_mul_f32 v144, v86, v32
  v_mul_f32 v145, v86, v33
  v_mul_f32 v146, v86, v34
  v_mul_f32 v147, v86, v35
  v_cvt_pk_bf16_f32 v136, v144, v145
  v_cvt_pk_bf16_f32 v137, v146, v147
  v_mul_f32 v148, v86, v36
  v_mul_f32 v149, v86, v37
  v_mul_f32 v150, v86, v38
  v_mul_f32 v151, v86, v39
  v_cvt_pk_bf16_f32 v138, v148, v149
  v_cvt_pk_bf16_f32 v139, v150, v151
  v_mul_f32 v144, v86, v16
  v_mul_f32 v145, v86, v17
  v_mul_f32 v146, v86, v18
  v_mul_f32 v147, v86, v19
  v_cvt_pk_bf16_f32 v140, v144, v145
  v_cvt_pk_bf16_f32 v141, v146, v147
  v_mul_f32 v148, v86, v20
  v_mul_f32 v149, v86, v21
  v_mul_f32 v150, v86, v22
  v_mul_f32 v151, v86, v23
  v_cvt_pk_bf16_f32 v142, v148, v149
  v_cvt_pk_bf16_f32 v143, v150, v151
  s_mov_b64 exec, s[72:73]
  ds_write_b64 v162, v[136:137] offset:0
  ds_write_b64 v162, v[138:139] offset:16
  ds_write_b64 v162, v[140:141] offset:24
  s_mov_b64 exec, s[70:71]
  ds_write_b64 v162, v[138:139] offset:8
  ds_write_b64 v162, v[142:143] offset:32
  s_mov_b64 exec, -1
  v_mul_f32 v144, v88, v64
  v_mul_f32 v145, v88, v65
  v_mul_f32 v146, v88, v66
  v_mul_f32 v147, v88, v67
  v_cvt_pk_bf16_f32 v136, v144, v145
  v_cvt_pk_bf16_f32 v137, v146, v147
  v_mul_f32 v148, v88, v68
  v_mul_f32 v149, v88, v69
  v_mul_f32 v150, v88, v70
  v_mul_f32 v151, v88, v71
  v_cvt_pk_bf16_f32 v138, v148, v149
  v_cvt_pk_bf16_f32 v139, v150, v151
  v_mul_f32 v144, v88, v48
  v_mul_f32 v145, v88, v49
  v_mul_f32 v146, v88, v50
  v_mul_f32 v147, v88, v51
  v_cvt_pk_bf16_f32 v140, v144, v145
  v_cvt_pk_bf16_f32 v141, v146, v147
  v_mul_f32 v148, v88, v52
  v_mul_f32 v149, v88, v53
  v_mul_f32 v150, v88, v54
  v_mul_f32 v151, v88, v55
  v_cvt_pk_bf16_f32 v142, v148, v149
  v_cvt_pk_bf16_f32 v143, v150, v151
  s_mov_b64 exec, s[72:73]
  ds_write_b64 v162, v[136:137] offset:1280
  ds_write_b64 v162, v[138:139] offset:1296
  ds_write_b64 v162, v[140:141] offset:1304
  s_mov_b64 exec, s[70:71]
  ds_write_b64 v162, v[138:139] offset:1288
  ds_write_b64 v162, v[142:143] offset:1312
  s_mov_b64 exec, -1
  s_cmp_ge_u32 s3, 4
  s_cbranch_scc0 L_py1
  s_setprio 1
L_py1:
  v_max3_f32 v142, v104, v105, v106
  v_max3_f32 v24, v120, v121, v122
  v_min3_f32 v144, v104, v105, v106
  v_min3_f32 v26, v120, v121, v122
  v_max3_f32 v143, v107, v108, v109
  v_max3_f32 v25, v123, v124, v125
  v_min3_f32 v145, v107, v108, v109
  v_min3_f32 v27, v123, v124, v125
  v_max3_f32 v142, v142, v110, v111
  v_max3_f32 v24, v24, v126, v127
  v_min3_f32 v144, v144, v110, v111
  v_min3_f32 v26, v26, v126, v127
  v_max3_f32 v143, v143, v112, v113
  v_max3_f32 v25, v25, v128, v129
  v_min3_f32 v145, v145, v112, v113
  v_min3_f32 v27, v27, v128, v129
  v_max3_f32 v142, v142, v114, v115
  v_max3_f32 v24, v24, v130, v131
  v_min3_f32 v144, v144, v114, v115
  v_min3_f32 v26, v26, v130, v131
  v_max_f32 v142, v142, v143
  v_max_f32 v24, v24, v25
  v_min_f32 v144, v144, v145
  v_min_f32 v26, v26, v27
  v_mov_b32 v143, v142
  v_mov_b32 v25, v24
  v_mov_b32 v145, v144
  v_mov_b32 v27, v26
  v_permlane32_swap_b32 v142, v143
  v_permlane32_swap_b32 v24, v25
  v_permlane32_swap_b32 v144, v145
  v_permlane32_swap_b32 v26, v27
  v_max_f32 v142, v142, v143
  v_max_f32 v24, v24, v25
  v_min_f32 v144, v144, v145
  v_min_f32 v26, v26, v27
  v_mul_f32 v142, v142, v90
  v_mul_f32 v24, v24, v92
  v_mul_f32 v144, v144, v90
  v_mul_f32 v26, v26, v92
  v_fma_f32 v150, -v104, v90, v144
  v_fma_f32 v56, -v120, v92, v26
  v_fma_f32 v104, v104, v90, -v142
  v_fma_f32 v120, v120, v92, -v24
  v_fma_f32 v151, -v105, v90, v144
  v_fma_f32 v57, -v121, v92, v26
  v_fma_f32 v105, v105, v90, -v142
  v_fma_f32 v121, v121, v92, -v24
  v_fma_f32 v152, -v106, v90, v144
  v_fma_f32 v58, -v122, v92, v26
  v_fma_f32 v106, v106, v90, -v142
  v_fma_f32 v122, v122, v92, -v24
  v_fma_f32 v153, -v107, v90, v144
  v_fma_f32 v59, -v123, v92, v26
  v_fma_f32 v107, v107, v90, -v142
  v_fma_f32 v123, v123, v92, -v24
  v_fma_f32 v154, -v108, v90, v144
  v_fma_f32 v60, -v124, v92, v26
  v_fma_f32 v108, v108, v90, -v142
  v_fma_f32 v124, v124, v92, -v24
  v_fma_f32 v155, -v109, v90, v144
  v_fma_f32 v61, -v125, v92, v26
  v_fma_f32 v109, v109, v90, -v142
  v_fma_f32 v125, v125, v92, -v24
  v_fma_f32 v156, -v110, v90, v144
  v_fma_f32 v62, -v126, v92, v26
  v_fma_f32 v110, v110, v90, -v142
  v_fma_f32 v126, v126, v92, -v24
  v_fma_f32 v157, -v111, v90, v144
  v_fma_f32 v63, -v127, v92, v26
  v_fma_f32 v111, v111, v90, -v142
  v_fma_f32 v127, v127, v92, -v24
  v_fma_f32 v158, -v112, v90, v144
  v_fma_f32 v64, -v128, v92, v26
  v_fma_f32 v112, v112, v90, -v142
  v_fma_f32 v128, v128, v92, -v24
  v_fma_f32 v159, -v113, v90, v144
  v_fma_f32 v65, -v129, v92, v26
  v_fma_f32 v113, v113, v90, -v142
  v_fma_f32 v129, v129, v92, -v24
  v_fma_f32 v160, -v114, v90, v144
  v_fma_f32 v66, -v130, v92, v26
  v_fma_f32 v114, v114, v90, -v142
  v_fma_f32 v130, v130, v92, -v24
  v_fma_f32 v161, -v115, v90, v144
  v_fma_f32 v67, -v131, v92, v26
  v_fma_f32 v115, v115, v90, -v142
  v_fma_f32 v131, v131, v92, -v24
  v_exp_f32 v150, v150
  v_exp_f32 v56, v56
  v_exp_f32 v104, v104
  v_exp_f32 v120, v120
  v_exp_f32 v151, v151
  v_exp_f32 v57, v57
  v_exp_f32 v105, v105
  v_exp_f32 v121, v121
  v_exp_f32 v152, v152
  v_exp_f32 v58, v58
  v_exp_f32 v106, v106
  v_exp_f32 v122, v122
  v_exp_f32 v153, v153
  v_exp_f32 v59, v59
  v_exp_f32 v107, v107
  v_exp_f32 v123, v123
  v_exp_f32 v154, v154
  v_exp_f32 v60, v60
  v_exp_f32 v108, v108
  v_exp_f32 v124, v124
  v_exp_f32 v155, v155
  v_exp_f32 v61, v61
  v_exp_f32 v109, v109
  v_exp_f32 v125, v125
  v_exp_f32 v156, v156
  v_exp_f32 v62, v62
  v_exp_f32 v110, v110
  v_exp_f32 v126, v126
  v_exp_f32 v157, v157
  v_exp_f32 v63, v63
  v_exp_f32 v111, v111
  v_exp_f32 v127, v127
  v_exp_f32 v158, v158
  v_exp_f32 v64, v64
  v_exp_f32 v112, v112
  v_exp_f32 v128, v128
  v_exp_f32 v159, v159
  v_exp_f32 v65, v65
  v_exp_f32 v113, v113
  v_exp_f32 v129, v129
  v_exp_f32 v160, v160
  v_exp_f32 v66, v66
  v_exp_f32 v114, v114
  v_exp_f32 v130, v130
  v_exp_f32 v161, v161
  v_exp_f32 v67, v67
  v_exp_f32 v115, v115
  v_exp_f32 v131, v131
  v_add_f32 v146, v112, v113
  v_add_f32 v28, v128, v129
  v_add_f32 v148, v158, v159
  v_add_f32 v30, v64, v65
  v_add_f32 v142, v114, v115
  v_add_f32 v24, v130, v131
  v_add_f32 v143, v160, v161
  v_add_f32 v25, v66, v67
  v_add_f32 v144, v104, v105
  v_add_f32 v26, v120, v121
  v_add_f32 v145, v150, v151
  v_add_f32 v27, v56, v57
  v_add_f32 v146, v146, v142
  v_add_f32 v28, v28, v24
  v_add_f32 v148, v148, v143
  v_add_f32 v30, v30, v25
  v_add_f32 v142, v106, v107
  v_add_f32 v24, v122, v123
  v_add_f32 v143, v152, v153
  v_add_f32 v25, v58, v59
  v_mul_f32 v146, v80, v146
  v_mul_f32 v28, v80, v28
  v_mul_f32 v148, v80, v148
  v_mul_f32 v30, v80, v30
  v_add_f32 v144, v144, v142
  v_add_f32 v26, v26, v24
  v_add_f32 v145, v145, v143
  v_add_f32 v27, v27, v25
  v_add_f32 v142, v108, v109
  v_add_f32 v24, v124, v125
  v_add_f32 v143, v154, v155
  v_add_f32 v25, v60, v61
  v_add_f32 v146, v146, v144
  v_add_f32 v28, v28, v26
  v_add_f32 v148, v148, v145
  v_add_f32 v30, v30, v27
  v_add_f32 v144, v110, v111
  v_add_f32 v26, v126, v127
  v_add_f32 v145, v156, v157
  v_add_f32 v27, v62, v63
  v_add_f32 v146, v146, v142
  v_add_f32 v28, v28, v24
  v_add_f32 v148, v148, v143
  v_add_f32 v30, v30, v25
  v_add_f32 v146, v146, v144
  v_add_f32 v28, v28, v26
  v_add_f32 v148, v148, v145
  v_add_f32 v30, v30, v27
  v_mov_b32 v142, v146
  v_mov_b32 v24, v28
  v_mov_b32 v143, v148
  v_mov_b32 v25, v30
  v_permlane32_swap_b32 v146, v142
  v_permlane32_swap_b32 v28, v24
  v_permlane32_swap_b32 v148, v143
  v_permlane32_swap_b32 v30, v25
  v_add_f32 v146, v146, v142
  v_add_f32 v28, v28, v24
  v_add_f32 v148, v148, v143
  v_add_f32 v30, v30, v25
  v_rcp_f32 v146, v146
  v_rcp_f32 v28, v28
  v_rcp_f32 v148, v148
  v_rcp_f32 v30, v30
  v_mul_f32 v104, v146, v104
  v_mul_f32 v120, v28, v120
  v_mul_f32 v150, v148, v150
  v_mul_f32 v56, v30, v56
  v_mul_f32 v105, v146, v105
  v_mul_f32 v121, v28, v121
  v_mul_f32 v151, v148, v151
  v_mul_f32 v57, v30, v57
  v_mul_f32 v106, v146, v106
  v_mul_f32 v122, v28, v122
  v_mul_f32 v152, v148, v152
  v_mul_f32 v58, v30, v58
  v_mul_f32 v107, v146, v107
  v_mul_f32 v123, v28, v123
  v_mul_f32 v153, v148, v153
  v_mul_f32 v59, v30, v59
  v_mul_f32 v108, v146, v108
  v_mul_f32 v124, v28, v124
  v_mul_f32 v154, v148, v154
  v_mul_f32 v60, v30, v60
  v_mul_f32 v109, v146, v109
  v_mul_f32 v125, v28, v125
  v_mul_f32 v155, v148, v155
  v_mul_f32 v61, v30, v61
  v_mul_f32 v110, v146, v110
  v_mul_f32 v126, v28, v126
  v_mul_f32 v156, v148, v156
  v_mul_f32 v62, v30, v62
  v_mul_f32 v111, v146, v111
  v_mul_f32 v127, v28, v127
  v_mul_f32 v157, v148, v157
  v_mul_f32 v63, v30, v63
  v_mul_f32 v112, v146, v112
  v_mul_f32 v128, v28, v128
  v_mul_f32 v158, v148, v158
  v_mul_f32 v64, v30, v64
  v_mul_f32 v113, v146, v113
  v_mul_f32 v129, v28, v129
  v_mul_f32 v159, v148, v159
  v_mul_f32 v65, v30, v65
  v_mul_f32 v114, v146, v114
  v_mul_f32 v130, v28, v130
  v_mul_f32 v160, v148, v160
  v_mul_f32 v66, v30, v66
  v_mul_f32 v115, v146, v115
  v_mul_f32 v131, v28, v131
  v_mul_f32 v161, v148, v161
  v_mul_f32 v67, v30, v67
  v_cvt_pk_bf16_f32 v98, v104, v105
  v_cvt_pk_bf16_f32 v32, v120, v121
  v_cvt_pk_bf16_f32 v136, v150, v151
  v_cvt_pk_bf16_f32 v82, v56, v57
  v_cvt_pk_bf16_f32 v99, v106, v107
  v_cvt_pk_bf16_f32 v33, v122, v123
  v_cvt_pk_bf16_f32 v137, v152, v153
  v_cvt_pk_bf16_f32 v83, v58, v59
  v_cvt_pk_bf16_f32 v100, v108, v109
  v_cvt_pk_bf16_f32 v34, v124, v125
  v_cvt_pk_bf16_f32 v138, v154, v155
  v_cvt_pk_bf16_f32 v84, v60, v61
  v_cvt_pk_bf16_f32 v101, v110, v111
  v_cvt_pk_bf16_f32 v35, v126, v127
  v_cvt_pk_bf16_f32 v139, v156, v157
  v_cvt_pk_bf16_f32 v85, v62, v63
  v_cvt_pk_bf16_f32 v102, v112, v113
  v_cvt_pk_bf16_f32 v36, v128, v129
  v_cvt_pk_bf16_f32 v140, v158, v159
  v_cvt_pk_bf16_f32 v86, v64, v65
  v_cvt_pk_bf16_f32 v103, v114, v115
  v_cvt_pk_bf16_f32 v37, v130, v131
  v_cvt_pk_bf16_f32 v141, v160, v161
  v_cvt_pk_bf16_f32 v87, v66, v67
  ds_write_b64 v163, v[98:99] offset:0
  ds_write_b64 v163, v[100:101] offset:16
  ds_write_b64 v163, v[136:137] offset:5120
  ds_write_b64 v163, v[138:139] offset:5136
  ds_write_b64 v163, v[32:33] offset:1280
  ds_write_b64 v163, v[34:35] offset:1296
  ds_write_b64 v163, v[82:83] offset:6400
  ds_write_b64 v163, v[84:85] offset:6416
  s_mov_b64 exec, s[70:71]
  ds_write_b64 v163, v[102:103] offset:32
  ds_write_b64 v163, v[140:141] offset:5152
  ds_write_b64 v163, v[36:37] offset:1312
  ds_write_b64 v163, v[86:87] offset:6432
  s_mov_b64 exec, -1
  v_bfe_u32 v1, v0, 2, 2
  v_lshlrev_b32 v1, 3, v1
  v_lshrrev_b32 v2, 5, v0
  v_lshl_add_u32 v1, v2, 1, v1
  v_mul_u32_u24 v1, 40, v1
  v_bfe_u32 v2, v0, 4, 1
  v_and_b32 v3, 3, v0
  v_lshl_add_u32 v2, v2, 2, v3
  v_lshl_add_u32 v3, v2, 3, v1
  s_mul_i32 s12, s10, 10240
  s_mul_i32 s13, s9, 5120
  s_add_u32 s12, s12, s13
  s_add_u32 s12, s12, 81920
  v_add_u32 v4, s12, v3
  s_mul_i32 s12, s10, 5120
  s_add_u32 s12, s12, 122880
  v_add_u32 v5, s12, v3
  v_and_b32 v7, 31, v0
  v_cmp_le_u32 vcc, 24, v7
  s_setprio 0
  s_waitcnt lgkmcnt(0)
  s_barrier
  ds_read_b64_tr_b16 v[104:105], v4 offset:0
  ds_read_b64_tr_b16 v[106:107], v4 offset:40
  ds_read_b64_tr_b16 v[108:109], v5 offset:0
  ds_read_b64_tr_b16 v[110:111], v5 offset:40
  ds_read_b64_tr_b16 v[112:113], v4 offset:160
  ds_read_b64_tr_b16 v[114:115], v4 offset:200
  ds_read_b64_tr_b16 v[116:117], v5 offset:160
  ds_read_b64_tr_b16 v[118:119], v5 offset:200
  ds_read_b64_tr_b16 v[120:121], v4 offset:1280
  ds_read_b64_tr_b16 v[122:123], v4 offset:1320
  ds_read_b64_tr_b16 v[124:125], v5 offset:1280
  ds_read_b64_tr_b16 v[126:127], v5 offset:1320
  s_waitcnt lgkmcnt(8)
  ds_read_b64_tr_b16 v[128:129], v4 offset:1440
  ds_read_b64_tr_b16 v[130:131], v4 offset:1480
  ds_read_b64_tr_b16 v[132:133], v5 offset:1440
  ds_read_b64_tr_b16 v[134:135], v5 offset:1480
  v_cndmask_b32 v108, v108, v81, vcc
  v_cndmask_b32 v109, v109, v81, vcc
  v_cndmask_b32 v110, v110, v81, vcc
  v_cndmask_b32 v111, v111, v81, vcc
  s_nop 1
  v_mfma_f32_32x32x16_bf16 v[24:39], v[104:107], v[108:111], 0
  s_waitcnt lgkmcnt(8)
  ds_read_b64_tr_b16 v[104:105], v4 offset:2560
  ds_read_b64_tr_b16 v[106:107], v4 offset:2600
  ds_read_b64_tr_b16 v[108:109], v5 offset:2560
  ds_read_b64_tr_b16 v[110:111], v5 offset:2600
  v_cndmask_b32 v116, v116, v81, vcc
  v_cndmask_b32 v117, v117, v81, vcc
  v_cndmask_b32 v118, v118, v81, vcc
  v_cndmask_b32 v119, v119, v81, vcc
  s_nop 1
  v_mfma_f32_32x32x16_bf16 v[24:39], v[112:115], v[116:119], v[24:39]
  s_waitcnt lgkmcnt(8)
  ds_read_b64_tr_b16 v[112:113], v4 offset:2720
  ds_read_b64_tr_b16 v[114:115], v4 offset:2760
  ds_read_b64_tr_b16 v[116:117], v5 offset:2720
  ds_read_b64_tr_b16 v[118:119], v5 offset:2760
  v_cndmask_b32 v124, v124, v81, vcc
  v_cndmask_b32 v125, v125, v81, vcc
  v_cndmask_b32 v126, v126, v81, vcc
  v_cndmask_b32 v127, v127, v81, vcc
  s_nop 1
  v_mfma_f32_32x32x16_bf16 v[24:39], v[120:123], v[124:127], v[24:39]
  s_waitcnt lgkmcnt(8)
  ds_read_b64_tr_b16 v[120:121], v4 offset:3840
  ds_read_b64_tr_b16 v[122:123], v4 offset:3880
  ds_read_b64_tr_b16 v[124:125], v5 offset:3840
  ds_read_b64_tr_b16 v[126:127], v5 offset:3880
  v_cndmask_b32 v132, v132, v81, vcc
  v_cndmask_b32 v133, v133, v81, vcc
  v_cndmask_b32 v134, v134, v81, vcc
  v_cndmask_b32 v135, v135, v81, vcc
  s_nop 1
  v_mfma_f32_32x32x16_bf16 v[24:39], v[128:131], v[132:135], v[24:39]
  s_waitcnt lgkmcnt(8)
  ds_read_b64_tr_b16 v[128:129], v4 offset:4000
  ds_read_b64_tr_b16 v[130:131], v4 offset:4040
  ds_read_b64_tr_b16 v[132:133], v5 offset:4000
  ds_read_b64_tr_b16 v[134:135], v5 offset:4040
  v_cndmask_b32 v108, v108, v81, vcc
  v_cndmask_b32 v109, v109, v81, vcc
  v_cndmask_b32 v110, v110, v81, vcc
  v_cndmask_b32 v111, v111, v81, vcc
  s_nop 1
  v_mfma_f32_32x32x16_bf16 v[24:39], v[104:107], v[108:111], v[24:39]
  s_waitcnt lgkmcnt(8)
  v_cndmask_b32 v116, v116, v81, vcc
  v_cndmask_b32 v117, v117, v81, vcc
  v_cndmask_b32 v118, v118, v81, vcc
  v_cndmask_b32 v119, v119, v81, vcc
  s_nop 1
  v_mfma_f32_32x32x16_bf16 v[24:39], v[112:115], v[116:119], v[24:39]
  s_waitcnt lgkmcnt(4)
  v_cndmask_b32 v124, v124, v81, vcc
  v_cndmask_b32 v125, v125, v81, vcc
  v_cndmask_b32 v126, v126, v81, vcc
  v_cndmask_b32 v127, v127, v81, vcc
  s_nop 1
  v_mfma_f32_32x32x16_bf16 v[24:39], v[120:123], v[124:127], v[24:39]
  s_waitcnt lgkmcnt(0)
  v_cndmask_b32 v132, v132, v81, vcc
  v_cndmask_b32 v133, v133, v81, vcc
  v_cndmask_b32 v134, v134, v81, vcc
  v_cndmask_b32 v135, v135, v81, vcc
  s_nop 1
  v_mfma_f32_32x32x16_bf16 v[24:39], v[128:131], v[132:135], v[24:39]
  s_add_u32 s48, s36, 1048576
  s_addc_u32 s49, s37, 0
  s_mov_b32 s50, 1048576
  s_mov_b32 s51, 0x20000
  v_and_b32 v1, 31, v0
  v_min_u32 v2, 20, v1
  v_lshrrev_b32 v3, 5, v0
  v_mul_u32_u24 v3, 21, v3
  v_add_u32 v2, v2, v3
  v_mul_u32_u24 v165, 24, v2
  s_lshl_b32 s12, s5, 4
  s_add_u32 s12, s12, s4
  s_lshl_b32 s12, s12, 3
  s_lshl_b32 s13, s10, 1
  s_add_u32 s13, s13, s9
  s_add_u32 s12, s12, s13
  s_lshl_b32 s12, s12, 10
  v_cmp_gt_u32 vcc, 20, v1
  v_cmp_eq_u32 s[14:15], 24, v1
  s_nop 0
  s_or_b64 vcc, vcc, s[14:15]
  v_cvt_pk_bf16_f32 v142, v24, v25
  v_cvt_pk_bf16_f32 v143, v26, v27
  v_cvt_pk_bf16_f32 v144, v28, v29
  v_cvt_pk_bf16_f32 v145, v30, v31
  v_cvt_pk_bf16_f32 v146, v32, v33
  v_cvt_pk_bf16_f32 v147, v34, v35
  v_xor_b32 v148, v142, v143
  v_xor_b32 v149, v144, v145
  v_xor_b32 v150, v146, v147
  v_xor_b32 v148, v148, v149
  v_xor_b32 v148, v148, v150
  v_cndmask_b32 v148, 0, v148, vcc
  s_nop 1
  v_xor_b32_dpp v148, v148, v148 row_ror:8 row_mask:0xf bank_mask:0xf
  s_nop 1
  v_xor_b32_dpp v148, v148, v148 row_ror:4 row_mask:0xf bank_mask:0xf
  s_nop 1
  v_xor_b32_dpp v148, v148, v148 row_ror:2 row_mask:0xf bank_mask:0xf
  s_nop 1
  v_xor_b32_dpp v148, v148, v148 row_ror:1 row_mask:0xf bank_mask:0xf
  v_mov_b32 v149, v148
  s_nop 1
  v_permlane16_swap_b32 v148, v149
  v_xor_b32 v148, v148, v149
  v_mov_b32 v149, v148
  s_nop 1
  v_permlane32_swap_b32 v148, v149
  v_xor_b32 v149, v148, v149
  v_mov_b32 v148, s11
  v_mov_b32 v150, s11
  v_mov_b32 v151, 0
  v_mov_b32 v152, 1008
  s_mov_b64 exec, vcc
  buffer_store_dwordx4 v[142:145], v165, s[48:51], s12 offen sc1
  buffer_store_dwordx2 v[146:147], v165, s[48:51], s12 offen offset:16 sc1
  s_mov_b64 exec, 1
  buffer_store_dwordx4 v[148:151], v152, s[48:51], s12 offen sc1
  s_mov_b64 exec, -1
  s_barrier
  v_cvt_pk_bf16_f32 v8, v8, v9
  v_cvt_pk_bf16_f32 v9, v10, v11
  v_cvt_pk_bf16_f32 v10, v12, v13
  v_cvt_pk_bf16_f32 v11, v14, v15
  v_cvt_pk_bf16_f32 v12, v16, v17
  v_cvt_pk_bf16_f32 v13, v18, v19
  v_cvt_pk_bf16_f32 v14, v20, v21
  v_cvt_pk_bf16_f32 v15, v22, v23
  v_cvt_pk_bf16_f32 v40, v40, v41
  v_cvt_pk_bf16_f32 v41, v42, v43
  v_cvt_pk_bf16_f32 v42, v44, v45
  v_cvt_pk_bf16_f32 v43, v46, v47
  v_cvt_pk_bf16_f32 v44, v48, v49
  v_cvt_pk_bf16_f32 v45, v50, v51
  v_cvt_pk_bf16_f32 v46, v52, v53
  v_cvt_pk_bf16_f32 v47, v54, v55
  v_mfma_f32_32x32x16_bf16 v[104:119], v[72:75], v[8:11], 0
  v_mfma_f32_32x32x16_bf16 v[104:119], v[76:79], v[12:15], v[104:119]
  v_mfma_f32_32x32x16_bf16 v[120:135], v[72:75], v[40:43], 0
  v_mfma_f32_32x32x16_bf16 v[120:135], v[76:79], v[44:47], v[120:135]
  s_nop 9
  v_max3_f32 v142, v104, v105, v106
  s_nop 0
  v_max3_f32 v24, v120, v121, v122
  v_min3_f32 v144, v104, v105, v106
  v_min3_f32 v26, v120, v121, v122
  v_max3_f32 v143, v107, v108, v109
  v_max3_f32 v25, v123, v124, v125
  v_min3_f32 v145, v107, v108, v109
  v_min3_f32 v27, v123, v124, v125
  v_max3_f32 v142, v142, v110, v111
  v_max3_f32 v24, v24, v126, v127
  v_min3_f32 v144, v144, v110, v111
  v_min3_f32 v26, v26, v126, v127
  v_max3_f32 v143, v143, v112, v113
  v_max3_f32 v25, v25, v128, v129
  v_min3_f32 v145, v145, v112, v113
  v_min3_f32 v27, v27, v128, v129
  v_max3_f32 v142, v142, v114, v115
  v_max3_f32 v24, v24, v130, v131
  v_min3_f32 v144, v144, v114, v115
  v_min3_f32 v26, v26, v130, v131
  v_max_f32 v142, v142, v143
  v_max_f32 v24, v24, v25
  v_min_f32 v144, v144, v145
  v_min_f32 v26, v26, v27
  v_mov_b32 v143, v142
  v_mov_b32 v25, v24
  v_mov_b32 v145, v144
  v_mov_b32 v27, v26
  v_permlane32_swap_b32 v142, v143
  v_permlane32_swap_b32 v24, v25
  v_permlane32_swap_b32 v144, v145
  v_permlane32_swap_b32 v26, v27
  v_max_f32 v142, v142, v143
  v_max_f32 v24, v24, v25
  v_min_f32 v144, v144, v145
  v_min_f32 v26, v26, v27
  v_mul_f32 v142, v142, v90
  v_mul_f32 v24, v24, v92
  v_mul_f32 v144, v144, v90
  v_mul_f32 v26, v26, v92
  v_fma_f32 v150, -v104, v90, v144
  v_fma_f32 v64, -v120, v92, v26
  v_fma_f32 v104, v104, v90, -v142
  v_fma_f32 v120, v120, v92, -v24
  v_fma_f32 v151, -v105, v90, v144
  v_fma_f32 v65, -v121, v92, v26
  v_fma_f32 v105, v105, v90, -v142
  v_fma_f32 v121, v121, v92, -v24
  v_fma_f32 v152, -v106, v90, v144
  v_fma_f32 v66, -v122, v92, v26
  v_fma_f32 v106, v106, v90, -v142
  v_fma_f32 v122, v122, v92, -v24
  v_fma_f32 v153, -v107, v90, v144
  v_fma_f32 v67, -v123, v92, v26
  v_fma_f32 v107, v107, v90, -v142
  v_fma_f32 v123, v123, v92, -v24
  v_fma_f32 v154, -v108, v90, v144
  v_fma_f32 v68, -v124, v92, v26
  v_fma_f32 v108, v108, v90, -v142
  v_fma_f32 v124, v124, v92, -v24
  v_fma_f32 v155, -v109, v90, v144
  v_fma_f32 v69, -v125, v92, v26
  v_fma_f32 v109, v109, v90, -v142
  v_fma_f32 v125, v125, v92, -v24
  v_fma_f32 v156, -v110, v90, v144
  v_fma_f32 v70, -v126, v92, v26
  v_fma_f32 v110, v110, v90, -v142
  v_fma_f32 v126, v126, v92, -v24
  v_fma_f32 v157, -v111, v90, v144
  v_fma_f32 v71, -v127, v92, v26
  v_fma_f32 v111, v111, v90, -v142
  v_fma_f32 v127, v127, v92, -v24
  v_fma_f32 v158, -v112, v90, v144
  v_fma_f32 v72, -v128, v92, v26
  v_fma_f32 v112, v112, v90, -v142
  v_fma_f32 v128, v128, v92, -v24
  v_fma_f32 v159, -v113, v90, v144
  v_fma_f32 v73, -v129, v92, v26
  v_fma_f32 v113, v113, v90, -v142
  v_fma_f32 v129, v129, v92, -v24
  v_fma_f32 v160, -v114, v90, v144
  v_fma_f32 v74, -v130, v92, v26
  v_fma_f32 v114, v114, v90, -v142
  v_fma_f32 v130, v130, v92, -v24
  v_fma_f32 v161, -v115, v90, v144
  v_fma_f32 v75, -v131, v92, v26
  v_fma_f32 v115, v115, v90, -v142
  v_fma_f32 v131, v131, v92, -v24
  v_exp_f32 v150, v150
  v_exp_f32 v64, v64
  v_exp_f32 v104, v104
  v_exp_f32 v120, v120
  v_exp_f32 v151, v151
  v_exp_f32 v65, v65
  v_exp_f32 v105, v105
  v_exp_f32 v121, v121
  v_exp_f32 v152, v152
  v_exp_f32 v66, v66
  v_exp_f32 v106, v106
  v_exp_f32 v122, v122
  v_exp_f32 v153, v153
  v_exp_f32 v67, v67
  v_exp_f32 v107, v107
  v_exp_f32 v123, v123
  v_exp_f32 v154, v154
  v_exp_f32 v68, v68
  v_exp_f32 v108, v108
  v_exp_f32 v124, v124
  v_exp_f32 v155, v155
  v_exp_f32 v69, v69
  v_exp_f32 v109, v109
  v_exp_f32 v125, v125
  v_exp_f32 v156, v156
  v_exp_f32 v70, v70
  v_exp_f32 v110, v110
  v_exp_f32 v126, v126
  v_exp_f32 v157, v157
  v_exp_f32 v71, v71
  v_exp_f32 v111, v111
  v_exp_f32 v127, v127
  v_exp_f32 v158, v158
  v_exp_f32 v72, v72
  v_exp_f32 v112, v112
  v_exp_f32 v128, v128
  v_exp_f32 v159, v159
  v_exp_f32 v73, v73
  v_exp_f32 v113, v113
  v_exp_f32 v129, v129
  v_exp_f32 v160, v160
  v_exp_f32 v74, v74
  v_exp_f32 v114, v114
  v_exp_f32 v130, v130
  v_exp_f32 v161, v161
  v_exp_f32 v75, v75
  v_exp_f32 v115, v115
  v_exp_f32 v131, v131
  v_add_f32 v146, v112, v113
  v_add_f32 v28, v128, v129
  v_add_f32 v148, v158, v159
  v_add_f32 v30, v72, v73
  v_add_f32 v142, v114, v115
  v_add_f32 v24, v130, v131
  v_add_f32 v143, v160, v161
  v_add_f32 v25, v74, v75
  v_add_f32 v144, v104, v105
  v_add_f32 v26, v120, v121
  v_add_f32 v145, v150, v151
  v_add_f32 v27, v64, v65
  v_add_f32 v146, v146, v142
  v_add_f32 v28, v28, v24
  v_add_f32 v148, v148, v143
  v_add_f32 v30, v30, v25
  v_add_f32 v142, v106, v107
  v_add_f32 v24, v122, v123
  v_add_f32 v143, v152, v153
  v_add_f32 v25, v66, v67
  v_mul_f32 v146, v80, v146
  v_mul_f32 v28, v80, v28
  v_mul_f32 v148, v80, v148
  v_mul_f32 v30, v80, v30
  v_add_f32 v144, v144, v142
  v_add_f32 v26, v26, v24
  v_add_f32 v145, v145, v143
  v_add_f32 v27, v27, v25
  v_add_f32 v142, v108, v109
  v_add_f32 v24, v124, v125
  v_add_f32 v143, v154, v155
  v_add_f32 v25, v68, v69
  v_add_f32 v146, v146, v144
  v_add_f32 v28, v28, v26
  v_add_f32 v148, v148, v145
  v_add_f32 v30, v30, v27
  v_add_f32 v144, v110, v111
  v_add_f32 v26, v126, v127
  v_add_f32 v145, v156, v157
  v_add_f32 v27, v70, v71
  v_add_f32 v146, v146, v142
  v_add_f32 v28, v28, v24
  v_add_f32 v148, v148, v143
  v_add_f32 v30, v30, v25
  v_add_f32 v146, v146, v144
  v_add_f32 v28, v28, v26
  v_add_f32 v148, v148, v145
  v_add_f32 v30, v30, v27
  v_mov_b32 v142, v146
  v_mov_b32 v24, v28
  v_mov_b32 v143, v148
  v_mov_b32 v25, v30
  v_permlane32_swap_b32 v146, v142
  v_permlane32_swap_b32 v28, v24
  v_permlane32_swap_b32 v148, v143
  v_permlane32_swap_b32 v30, v25
  v_add_f32 v146, v146, v142
  v_add_f32 v28, v28, v24
  v_add_f32 v148, v148, v143
  v_add_f32 v30, v30, v25
  v_rcp_f32 v146, v146
  v_rcp_f32 v28, v28
  v_rcp_f32 v148, v148
  v_rcp_f32 v30, v30
  v_mul_f32 v104, v146, v104
  v_mul_f32 v120, v28, v120
  v_mul_f32 v150, v148, v150
  v_mul_f32 v64, v30, v64
  v_mul_f32 v105, v146, v105
  v_mul_f32 v121, v28, v121
  v_mul_f32 v151, v148, v151
  v_mul_f32 v65, v30, v65
  v_mul_f32 v106, v146, v106
  v_mul_f32 v122, v28, v122
  v_mul_f32 v152, v148, v152
  v_mul_f32 v66, v30, v66
  v_mul_f32 v107, v146, v107
  v_mul_f32 v123, v28, v123
  v_mul_f32 v153, v148, v153
  v_mul_f32 v67, v30, v67
  v_mul_f32 v108, v146, v108
  v_mul_f32 v124, v28, v124
  v_mul_f32 v154, v148, v154
  v_mul_f32 v68, v30, v68
  v_mul_f32 v109, v146, v109
  v_mul_f32 v125, v28, v125
  v_mul_f32 v155, v148, v155
  v_mul_f32 v69, v30, v69
  v_mul_f32 v110, v146, v110
  v_mul_f32 v126, v28, v126
  v_mul_f32 v156, v148, v156
  v_mul_f32 v70, v30, v70
  v_mul_f32 v111, v146, v111
  v_mul_f32 v127, v28, v127
  v_mul_f32 v157, v148, v157
  v_mul_f32 v71, v30, v71
  v_mul_f32 v112, v146, v112
  v_mul_f32 v128, v28, v128
  v_mul_f32 v158, v148, v158
  v_mul_f32 v72, v30, v72
  v_mul_f32 v113, v146, v113
  v_mul_f32 v129, v28, v129
  v_mul_f32 v159, v148, v159
  v_mul_f32 v73, v30, v73
  v_mul_f32 v114, v146, v114
  v_mul_f32 v130, v28, v130
  v_mul_f32 v160, v148, v160
  v_mul_f32 v74, v30, v74
  v_mul_f32 v115, v146, v115
  v_mul_f32 v131, v28, v131
  v_mul_f32 v161, v148, v161
  v_mul_f32 v75, v30, v75
  v_cvt_pk_bf16_f32 v40, v104, v105
  v_cvt_pk_bf16_f32 v52, v120, v121
  v_cvt_pk_bf16_f32 v46, v150, v151
  v_cvt_pk_bf16_f32 v58, v64, v65
  v_cvt_pk_bf16_f32 v41, v106, v107
  v_cvt_pk_bf16_f32 v53, v122, v123
  v_cvt_pk_bf16_f32 v47, v152, v153
  v_cvt_pk_bf16_f32 v59, v66, v67
  v_cvt_pk_bf16_f32 v42, v108, v109
  v_cvt_pk_bf16_f32 v54, v124, v125
  v_cvt_pk_bf16_f32 v48, v154, v155
  v_cvt_pk_bf16_f32 v60, v68, v69
  v_cvt_pk_bf16_f32 v43, v110, v111
  v_cvt_pk_bf16_f32 v55, v126, v127
  v_cvt_pk_bf16_f32 v49, v156, v157
  v_cvt_pk_bf16_f32 v61, v70, v71
  v_cvt_pk_bf16_f32 v44, v112, v113
  v_cvt_pk_bf16_f32 v56, v128, v129
  v_cvt_pk_bf16_f32 v50, v158, v159
  v_cvt_pk_bf16_f32 v62, v72, v73
  v_cvt_pk_bf16_f32 v45, v114, v115
  v_cvt_pk_bf16_f32 v57, v130, v131
  v_cvt_pk_bf16_f32 v51, v160, v161
  v_cvt_pk_bf16_f32 v63, v74, v75
  v_lshlrev_b32 v20, 4, v0
  v_and_b32 v29, 7, v0
  v_lshrrev_b32 v5, 2, v29
  s_lshr_b32 s12, s7, 1
  s_lshl_b32 s12, s12, 3
  s_lshl_b32 s13, s10, 1
  s_add_u32 s12, s12, s13
  v_add_u32 v5, s12, v5
  v_lshlrev_b32 v5, 3, v5
  v_and_b32 v29, 3, v29
  s_and_b32 s13, s7, 1
  s_lshl_b32 s14, s13, 2
  v_add_u32 v7, s14, v29
  v_add_u32 v7, v7, v5
  v_lshlrev_b32 v7, 7, v7
  v_add_u32 v160, 14680064, v7
  v_lshlrev_b32 v29, 1, v29
  v_add_u32 v29, s13, v29
  v_add_u32 v29, v29, v5
  v_lshlrev_b32 v29, 7, v29
  v_add_u32 v161, 14942208, v29
  s_lshl_b32 s12, s5, 7
  s_lshl_b32 s13, s10, 1
  s_add_u32 s13, s13, s9
  s_add_u32 s12, s12, s13
  s_lshl_b32 s76, s12, 10
  s_mov_b32 s67, 0x00003f80
  s_mov_b32 s68, 0x3f800000
  s_mov_b32 s64, 0
L_kvr_58:
  s_add_u32 s13, s76, 0
  buffer_load_dwordx4 v[64:67], v20, s[48:51], s13 offen sc1
  s_add_u32 s13, s76, 8192
  buffer_load_dwordx4 v[68:71], v20, s[48:51], s13 offen sc1
  s_add_u32 s13, s76, 16384
  buffer_load_dwordx4 v[72:75], v20, s[48:51], s13 offen sc1
  s_add_u32 s13, s76, 24576
  buffer_load_dwordx4 v[76:79], v20, s[48:51], s13 offen sc1
  s_add_u32 s13, s76, 32768
  buffer_load_dwordx4 v[80:83], v20, s[48:51], s13 offen sc1
  s_add_u32 s13, s76, 40960
  buffer_load_dwordx4 v[84:87], v20, s[48:51], s13 offen sc1
  s_add_u32 s13, s76, 49152
  buffer_load_dwordx4 v[88:91], v20, s[48:51], s13 offen sc1
  s_add_u32 s13, s76, 57344
  buffer_load_dwordx4 v[92:95], v20, s[48:51], s13 offen sc1
  s_add_u32 s13, s76, 65536
  buffer_load_dwordx4 v[96:99], v20, s[48:51], s13 offen sc1
  s_add_u32 s13, s76, 73728
  buffer_load_dwordx4 v[100:103], v20, s[48:51], s13 offen sc1
  s_add_u32 s13, s76, 81920
  buffer_load_dwordx4 v[104:107], v20, s[48:51], s13 offen sc1
  s_add_u32 s13, s76, 90112
  buffer_load_dwordx4 v[108:111], v20, s[48:51], s13 offen sc1
  s_add_u32 s13, s76, 98304
  buffer_load_dwordx4 v[112:115], v20, s[48:51], s13 offen sc1
  s_add_u32 s13, s76, 106496
  buffer_load_dwordx4 v[116:119], v20, s[48:51], s13 offen sc1
  s_add_u32 s13, s76, 114688
  buffer_load_dwordx4 v[120:123], v20, s[48:51], s13 offen sc1
  s_add_u32 s13, s76, 122880
  buffer_load_dwordx4 v[124:127], v20, s[48:51], s13 offen sc1
  v_mov_b32 v21, 0
  v_mov_b32 v22, 0
  v_mov_b32 v23, 0
  s_waitcnt vmcnt(15)
  v_bitop3_b32 v21, v21, v64, v65 bitop3:0x96
  v_bitop3_b32 v22, v22, v66, v67 bitop3:0x96
  v_bitop3_b32 v23, v23, v64, s11 bitop3:0xf6
  s_waitcnt vmcnt(14)
  v_bitop3_b32 v21, v21, v68, v69 bitop3:0x96
  v_bitop3_b32 v22, v22, v70, v71 bitop3:0x96
  v_bitop3_b32 v23, v23, v68, s11 bitop3:0xf6
  s_waitcnt vmcnt(13)
  v_bitop3_b32 v21, v21, v72, v73 bitop3:0x96
  v_bitop3_b32 v22, v22, v74, v75 bitop3:0x96
  v_bitop3_b32 v23, v23, v72, s11 bitop3:0xf6
  s_waitcnt vmcnt(12)
  v_bitop3_b32 v21, v21, v76, v77 bitop3:0x96
  v_bitop3_b32 v22, v22, v78, v79 bitop3:0x96
  v_bitop3_b32 v23, v23, v76, s11 bitop3:0xf6
  s_waitcnt vmcnt(11)
  v_bitop3_b32 v21, v21, v80, v81 bitop3:0x96
  v_bitop3_b32 v22, v22, v82, v83 bitop3:0x96
  v_bitop3_b32 v23, v23, v80, s11 bitop3:0xf6
  s_waitcnt vmcnt(10)
  v_bitop3_b32 v21, v21, v84, v85 bitop3:0x96
  v_bitop3_b32 v22, v22, v86, v87 bitop3:0x96
  v_bitop3_b32 v23, v23, v84, s11 bitop3:0xf6
  s_waitcnt vmcnt(9)
  v_bitop3_b32 v21, v21, v88, v89 bitop3:0x96
  v_bitop3_b32 v22, v22, v90, v91 bitop3:0x96
  v_bitop3_b32 v23, v23, v88, s11 bitop3:0xf6
  s_waitcnt vmcnt(8)
  v_bitop3_b32 v21, v21, v92, v93 bitop3:0x96
  v_bitop3_b32 v22, v22, v94, v95 bitop3:0x96
  v_bitop3_b32 v23, v23, v92, s11 bitop3:0xf6
  s_waitcnt vmcnt(7)
  v_bitop3_b32 v21, v21, v96, v97 bitop3:0x96
  v_bitop3_b32 v22, v22, v98, v99 bitop3:0x96
  v_bitop3_b32 v23, v23, v96, s11 bitop3:0xf6
  s_waitcnt vmcnt(6)
  v_bitop3_b32 v21, v21, v100, v101 bitop3:0x96
  v_bitop3_b32 v22, v22, v102, v103 bitop3:0x96
  v_bitop3_b32 v23, v23, v100, s11 bitop3:0xf6
  s_waitcnt vmcnt(5)
  v_bitop3_b32 v21, v21, v104, v105 bitop3:0x96
  v_bitop3_b32 v22, v22, v106, v107 bitop3:0x96
  v_bitop3_b32 v23, v23, v104, s11 bitop3:0xf6
  s_waitcnt vmcnt(4)
  v_bitop3_b32 v21, v21, v108, v109 bitop3:0x96
  v_bitop3_b32 v22, v22, v110, v111 bitop3:0x96
  v_bitop3_b32 v23, v23, v108, s11 bitop3:0xf6
  s_waitcnt vmcnt(3)
  v_bitop3_b32 v21, v21, v112, v113 bitop3:0x96
  v_bitop3_b32 v22, v22, v114, v115 bitop3:0x96
  v_bitop3_b32 v23, v23, v112, s11 bitop3:0xf6
  s_waitcnt vmcnt(2)
  v_bitop3_b32 v21, v21, v116, v117 bitop3:0x96
  v_bitop3_b32 v22, v22, v118, v119 bitop3:0x96
  v_bitop3_b32 v23, v23, v116, s11 bitop3:0xf6
  s_waitcnt vmcnt(1)
  v_bitop3_b32 v21, v21, v120, v121 bitop3:0x96
  v_bitop3_b32 v22, v22, v122, v123 bitop3:0x96
  v_bitop3_b32 v23, v23, v120, s11 bitop3:0xf6
  s_waitcnt vmcnt(0)
  v_bitop3_b32 v21, v21, v124, v125 bitop3:0x96
  v_bitop3_b32 v22, v22, v126, v127 bitop3:0x96
  v_bitop3_b32 v23, v23, v124, s11 bitop3:0xf6
  v_xor_b32 v21, v21, v22
  s_nop 1
  v_xor_b32_dpp v21, v21, v21 row_ror:8 row_mask:0xf bank_mask:0xf
  s_nop 1
  v_xor_b32_dpp v21, v21, v21 row_ror:4 row_mask:0xf bank_mask:0xf
  s_nop 1
  v_xor_b32_dpp v21, v21, v21 row_ror:2 row_mask:0xf bank_mask:0xf
  s_nop 1
  v_xor_b32_dpp v21, v21, v21 row_ror:1 row_mask:0xf bank_mask:0xf
  v_mov_b32 v22, v21
  s_nop 1
  v_permlane16_swap_b32 v21, v22
  v_xor_b32 v21, v21, v22
  v_mov_b32 v22, v21
  s_nop 1
  v_permlane32_swap_b32 v21, v22
  v_xor_b32 v21, v21, v22
  v_readlane_b32 s13, v23, 63
  v_readfirstlane_b32 s14, v21
  s_nop 0
  s_or_b32 s13, s13, s14
  s_cmp_eq_u32 s13, 0
  s_cbranch_scc1 L_kvg_59
  s_add_u32 s64, s64, 1
  s_cmp_gt_u32 s64, 12500
  s_cbranch_scc1 L_kvg_59
  s_sleep 2
  s_branch L_kvr_58
L_kvg_59:
  v_mov_b32 v8, 0
  v_mov_b32 v9, 0
  v_mov_b32 v10, 0
  v_mov_b32 v11, 0
  v_mov_b32 v12, 0
  v_mov_b32 v13, 0
  v_mov_b32 v14, 0
  v_mov_b32 v15, 0
  s_lshl_b32 s12, s10, 1
  s_add_u32 s12, s12, s9
  s_lshl_b32 s12, s12, 10
  s_add_u32 s12, s12, 147712
  v_lshl_add_u32 v1, v0, 4, s12
  s_lshl_b32 s12, s10, 11
  s_add_u32 s12, s12, 147712
  v_add_u32 v2, s12, v165
  s_waitcnt vmcnt(15)
  v_dot2c_f32_bf16 v8, s67, v64
  v_dot2c_f32_bf16 v9, s68, v64
  v_dot2c_f32_bf16 v10, s67, v65
  v_dot2c_f32_bf16 v11, s68, v65
  v_dot2c_f32_bf16 v12, s67, v66
  v_dot2c_f32_bf16 v13, s68, v66
  v_dot2c_f32_bf16 v14, s67, v67
  v_dot2c_f32_bf16 v15, s68, v67
  s_waitcnt vmcnt(14)
  v_dot2c_f32_bf16 v8, s67, v68
  v_dot2c_f32_bf16 v9, s68, v68
  v_dot2c_f32_bf16 v10, s67, v69
  v_dot2c_f32_bf16 v11, s68, v69
  v_dot2c_f32_bf16 v12, s67, v70
  v_dot2c_f32_bf16 v13, s68, v70
  v_dot2c_f32_bf16 v14, s67, v71
  v_dot2c_f32_bf16 v15, s68, v71
  s_waitcnt vmcnt(13)
  v_dot2c_f32_bf16 v8, s67, v72
  v_dot2c_f32_bf16 v9, s68, v72
  v_dot2c_f32_bf16 v10, s67, v73
  v_dot2c_f32_bf16 v11, s68, v73
  v_dot2c_f32_bf16 v12, s67, v74
  v_dot2c_f32_bf16 v13, s68, v74
  v_dot2c_f32_bf16 v14, s67, v75
  v_dot2c_f32_bf16 v15, s68, v75
  s_waitcnt vmcnt(12)
  v_dot2c_f32_bf16 v8, s67, v76
  v_dot2c_f32_bf16 v9, s68, v76
  v_dot2c_f32_bf16 v10, s67, v77
  v_dot2c_f32_bf16 v11, s68, v77
  v_dot2c_f32_bf16 v12, s67, v78
  v_dot2c_f32_bf16 v13, s68, v78
  v_dot2c_f32_bf16 v14, s67, v79
  v_dot2c_f32_bf16 v15, s68, v79
  s_waitcnt vmcnt(11)
  v_dot2c_f32_bf16 v8, s67, v80
  v_dot2c_f32_bf16 v9, s68, v80
  v_dot2c_f32_bf16 v10, s67, v81
  v_dot2c_f32_bf16 v11, s68, v81
  v_dot2c_f32_bf16 v12, s67, v82
  v_dot2c_f32_bf16 v13, s68, v82
  v_dot2c_f32_bf16 v14, s67, v83
  v_dot2c_f32_bf16 v15, s68, v83
  s_waitcnt vmcnt(10)
  v_dot2c_f32_bf16 v8, s67, v84
  v_dot2c_f32_bf16 v9, s68, v84
  v_dot2c_f32_bf16 v10, s67, v85
  v_dot2c_f32_bf16 v11, s68, v85
  v_dot2c_f32_bf16 v12, s67, v86
  v_dot2c_f32_bf16 v13, s68, v86
  v_dot2c_f32_bf16 v14, s67, v87
  v_dot2c_f32_bf16 v15, s68, v87
  s_waitcnt vmcnt(9)
  v_dot2c_f32_bf16 v8, s67, v88
  v_dot2c_f32_bf16 v9, s68, v88
  v_dot2c_f32_bf16 v10, s67, v89
  v_dot2c_f32_bf16 v11, s68, v89
  v_dot2c_f32_bf16 v12, s67, v90
  v_dot2c_f32_bf16 v13, s68, v90
  v_dot2c_f32_bf16 v14, s67, v91
  v_dot2c_f32_bf16 v15, s68, v91
  s_waitcnt vmcnt(8)
  v_dot2c_f32_bf16 v8, s67, v92
  v_dot2c_f32_bf16 v9, s68, v92
  v_dot2c_f32_bf16 v10, s67, v93
  v_dot2c_f32_bf16 v11, s68, v93
  v_dot2c_f32_bf16 v12, s67, v94
  v_dot2c_f32_bf16 v13, s68, v94
  v_dot2c_f32_bf16 v14, s67, v95
  v_dot2c_f32_bf16 v15, s68, v95
  s_waitcnt vmcnt(7)
  v_dot2c_f32_bf16 v8, s67, v96
  v_dot2c_f32_bf16 v9, s68, v96
  v_dot2c_f32_bf16 v10, s67, v97
  v_dot2c_f32_bf16 v11, s68, v97
  v_dot2c_f32_bf16 v12, s67, v98
  v_dot2c_f32_bf16 v13, s68, v98
  v_dot2c_f32_bf16 v14, s67, v99
  v_dot2c_f32_bf16 v15, s68, v99
  s_waitcnt vmcnt(6)
  v_dot2c_f32_bf16 v8, s67, v100
  v_dot2c_f32_bf16 v9, s68, v100
  v_dot2c_f32_bf16 v10, s67, v101
  v_dot2c_f32_bf16 v11, s68, v101
  v_dot2c_f32_bf16 v12, s67, v102
  v_dot2c_f32_bf16 v13, s68, v102
  v_dot2c_f32_bf16 v14, s67, v103
  v_dot2c_f32_bf16 v15, s68, v103
  s_waitcnt vmcnt(5)
  v_dot2c_f32_bf16 v8, s67, v104
  v_dot2c_f32_bf16 v9, s68, v104
  v_dot2c_f32_bf16 v10, s67, v105
  v_dot2c_f32_bf16 v11, s68, v105
  v_dot2c_f32_bf16 v12, s67, v106
  v_dot2c_f32_bf16 v13, s68, v106
  v_dot2c_f32_bf16 v14, s67, v107
  v_dot2c_f32_bf16 v15, s68, v107
  s_waitcnt vmcnt(4)
  v_dot2c_f32_bf16 v8, s67, v108
  v_dot2c_f32_bf16 v9, s68, v108
  v_dot2c_f32_bf16 v10, s67, v109
  v_dot2c_f32_bf16 v11, s68, v109
  v_dot2c_f32_bf16 v12, s67, v110
  v_dot2c_f32_bf16 v13, s68, v110
  v_dot2c_f32_bf16 v14, s67, v111
  v_dot2c_f32_bf16 v15, s68, v111
  s_waitcnt vmcnt(3)
  v_dot2c_f32_bf16 v8, s67, v112
  v_dot2c_f32_bf16 v9, s68, v112
  v_dot2c_f32_bf16 v10, s67, v113
  v_dot2c_f32_bf16 v11, s68, v113
  v_dot2c_f32_bf16 v12, s67, v114
  v_dot2c_f32_bf16 v13, s68, v114
  v_dot2c_f32_bf16 v14, s67, v115
  v_dot2c_f32_bf16 v15, s68, v115
  s_waitcnt vmcnt(2)
  v_dot2c_f32_bf16 v8, s67, v116
  v_dot2c_f32_bf16 v9, s68, v116
  v_dot2c_f32_bf16 v10, s67, v117
  v_dot2c_f32_bf16 v11, s68, v117
  v_dot2c_f32_bf16 v12, s67, v118
  v_dot2c_f32_bf16 v13, s68, v118
  v_dot2c_f32_bf16 v14, s67, v119
  v_dot2c_f32_bf16 v15, s68, v119
  s_waitcnt vmcnt(1)
  v_dot2c_f32_bf16 v8, s67, v120
  v_dot2c_f32_bf16 v9, s68, v120
  v_dot2c_f32_bf16 v10, s67, v121
  v_dot2c_f32_bf16 v11, s68, v121
  v_dot2c_f32_bf16 v12, s67, v122
  v_dot2c_f32_bf16 v13, s68, v122
  v_dot2c_f32_bf16 v14, s67, v123
  v_dot2c_f32_bf16 v15, s68, v123
  s_waitcnt vmcnt(0)
  v_dot2c_f32_bf16 v8, s67, v124
  v_dot2c_f32_bf16 v9, s68, v124
  v_dot2c_f32_bf16 v10, s67, v125
  v_dot2c_f32_bf16 v11, s68, v125
  v_dot2c_f32_bf16 v12, s67, v126
  v_dot2c_f32_bf16 v13, s68, v126
  v_dot2c_f32_bf16 v14, s67, v127
  v_dot2c_f32_bf16 v15, s68, v127
  v_cvt_pk_bf16_f32 v24, v8, v9
  v_cvt_pk_bf16_f32 v25, v10, v11
  v_cvt_pk_bf16_f32 v26, v12, v13
  v_cvt_pk_bf16_f32 v27, v14, v15
  ds_write_b128 v1, v[24:27]
  global_load_dword v163, v160, s[36:37] sc1
  v_mov_b32 v108, v44
  v_mov_b32 v109, v45
  v_mov_b32 v110, v50
  v_mov_b32 v111, v51
  v_mov_b32 v112, v56
  v_mov_b32 v113, v57
  v_mov_b32 v114, v62
  v_mov_b32 v115, v63
  v_and_b32 v1, 31, v0
  s_lshl_b32 s12, s9, 6
  v_add_u32 v1, s12, v1
  v_mul_u32_u24 v1, 176, v1
  s_mul_i32 s12, s10, 40
  v_add_u32 v1, s12, v1
  v_lshrrev_b32 v3, 5, v0
  v_lshl_add_u32 v1, v3, 3, v1
  v_add_u32 v1, 122880, v1
  s_add_u32 s48, s36, 5242880
  s_addc_u32 s49, s37, 0
  s_mov_b32 s50, 8912896
  s_mov_b32 s51, 0x20000
  s_and_b32 s13, s3, 1
  s_lshl_b32 s13, s13, 6
  v_add_u32 v5, s13, v0
  v_mul_u32_u24 v153, 176, v5
  v_add_u32 v153, 122880, v153
  s_lshr_b32 s12, s3, 1
  s_lshl_b32 s14, s12, 4
  v_add_u32 v153, s14, v153
  v_lshrrev_b32 v154, 4, v5
  s_lshl_b32 s14, s4, 3
  v_add_u32 v154, s14, v154
  v_mul_u32_u24 v154, 69632, v154
  v_and_b32 v5, 15, v5
  v_lshl_add_u32 v154, v5, 4, v154
  s_mul_i32 s14, s5, 10
  s_add_u32 s14, s14, s12
  s_add_u32 s14, s14, 0
  s_lshr_b32 s15, s14, 2
  s_add_u32 s15, s15, 48
  s_lshl_b32 s15, s15, 10
  s_and_b32 s14, s14, 3
  s_lshl_b32 s14, s14, 8
  s_add_u32 s76, s15, s14
  s_mul_i32 s14, s5, 10
  s_add_u32 s14, s14, s12
  s_add_u32 s14, s14, 4
  s_lshr_b32 s15, s14, 2
  s_add_u32 s15, s15, 48
  s_lshl_b32 s15, s15, 10
  s_and_b32 s14, s14, 3
  s_lshl_b32 s14, s14, 8
  s_add_u32 s77, s15, s14
  s_mul_i32 s14, s5, 10
  s_add_u32 s14, s14, s12
  s_add_u32 s14, s14, 8
  s_lshr_b32 s15, s14, 2
  s_add_u32 s15, s15, 48
  s_lshl_b32 s15, s15, 10
  s_and_b32 s14, s14, 3
  s_lshl_b32 s14, s14, 8
  s_add_u32 s78, s15, s14
  s_add_u32 s44, s36, 5242880
  s_addc_u32 s45, s37, 0
  s_mov_b32 s46, 8912896
  s_mov_b32 s47, 0x20000
  s_lshl_b32 s12, s7, 2
  s_lshl_b32 s13, s9, 1
  s_add_u32 s12, s12, s13
  s_mul_i32 s12, s12, 69632
  v_lshl_add_u32 v150, v0, 4, s12
  v_add_u32 v151, 69632, v150
  s_mul_i32 s86, s10, 12288
  s_mul_i32 s87, s10, 5120
  s_add_u32 s87, s87, 49152
  s_mov_b32 s52, s16
  s_mov_b32 s53, s17
  s_mov_b32 s54, 2621440
  s_mov_b32 s55, 0x20000
  v_and_b32 v4, 15, v0
  s_lshl_b32 s12, s7, 6
  s_lshl_b32 s13, s9, 5
  s_add_u32 s12, s12, s13
  v_add_u32 v4, s12, v4
  v_mul_u32_u24 v4, 1280, v4
  v_lshrrev_b32 v5, 4, v0
  v_lshl_add_u32 v4, v5, 3, v4
  s_mul_i32 s12, s8, 160
  v_add_u32 v4, s12, v4
  s_add_u32 s12, s10, 0
  s_cmp_ge_u32 s12, 5
  s_cselect_b32 s13, 20320, 0
  s_lshl_b32 s12, s12, 5
  s_add_u32 s96, s12, s13
  s_add_u32 s12, s10, 4
  s_cmp_ge_u32 s12, 5
  s_cselect_b32 s13, 20320, 0
  s_lshl_b32 s12, s12, 5
  s_add_u32 s97, s12, s13
  s_add_u32 s12, s10, 8
  s_cmp_ge_u32 s12, 5
  s_cselect_b32 s13, 20320, 0
  s_lshl_b32 s12, s12, 5
  s_add_u32 s98, s12, s13
  s_mul_i32 s12, s10, 10240
  v_lshl_add_u32 v6, v0, 4, s12
  s_lshl_b32 s12, s4, 3
  s_add_u32 s12, s12, s5
  s_lshl_b32 s12, s12, 3
  s_add_u32 s12, s12, s3
  s_lshl_b32 s12, s12, 7
  s_add_u32 s89, s12, 14942208
  s_waitcnt lgkmcnt(0)
  s_barrier
  ds_read_b64 v[96:97], v2
  ds_read_b64 v[98:99], v2 offset:8
  ds_read_b64 v[100:101], v2 offset:16
  ds_read_b64 v[102:103], v2 offset:1040
  ds_read_b64 v[104:105], v2 offset:1024
  ds_read_b64 v[106:107], v2 offset:1032
  v_cmp_gt_u32 vcc, 32, v0
  s_waitcnt lgkmcnt(0)
  s_nop 0
  v_cndmask_b32 v100, 0, v100, vcc
  v_cndmask_b32 v101, 0, v101, vcc
  v_cndmask_b32 v102, 0, v102, vcc
  v_cndmask_b32 v103, 0, v103, vcc
  v_mfma_f32_32x32x16_bf16 v[8:23], v[96:99], v[40:43], 0
  s_nop 0
  v_mfma_f32_32x32x16_bf16 v[8:23], v[100:103], v[108:111], v[8:23]
  v_mfma_f32_32x32x16_bf16 v[8:23], v[104:107], v[46:49], v[8:23]
  v_mfma_f32_32x32x16_bf16 v[64:79], v[96:99], v[52:55], 0
  v_mfma_f32_32x32x16_bf16 v[64:79], v[100:103], v[112:115], v[64:79]
  v_mfma_f32_32x32x16_bf16 v[64:79], v[104:107], v[58:61], v[64:79]
  s_nop 8
  v_add_f32 v20, 0x358637bd, v20
  v_rcp_f32 v20, v20
  s_nop 0
  v_mul_f32 v8, v20, v8
  v_mul_f32 v9, v20, v9
  v_mul_f32 v10, v20, v10
  v_mul_f32 v11, v20, v11
  v_mul_f32 v12, v20, v12
  v_mul_f32 v13, v20, v13
  v_mul_f32 v14, v20, v14
  v_mul_f32 v15, v20, v15
  v_mul_f32 v16, v20, v16
  v_mul_f32 v17, v20, v17
  v_mul_f32 v18, v20, v18
  v_mul_f32 v19, v20, v19
  v_cvt_pk_bf16_f32 v8, v8, v9
  v_cvt_pk_bf16_f32 v9, v10, v11
  v_cvt_pk_bf16_f32 v10, v12, v13
  v_cvt_pk_bf16_f32 v11, v14, v15
  v_cvt_pk_bf16_f32 v12, v16, v17
  v_cvt_pk_bf16_f32 v13, v18, v19
  ds_write_b64 v1, v[8:9] offset:0
  ds_write_b64 v1, v[10:11] offset:16
  s_mov_b64 exec, s[70:71]
  ds_write_b64 v1, v[12:13] offset:32
  s_mov_b64 exec, -1
  v_add_f32 v76, 0x358637bd, v76
  v_rcp_f32 v76, v76
  s_nop 0
  v_mul_f32 v64, v76, v64
  v_mul_f32 v65, v76, v65
  v_mul_f32 v66, v76, v66
  v_mul_f32 v67, v76, v67
  v_mul_f32 v68, v76, v68
  v_mul_f32 v69, v76, v69
  v_mul_f32 v70, v76, v70
  v_mul_f32 v71, v76, v71
  v_mul_f32 v72, v76, v72
  v_mul_f32 v73, v76, v73
  v_mul_f32 v74, v76, v74
  v_mul_f32 v75, v76, v75
  v_cvt_pk_bf16_f32 v64, v64, v65
  v_cvt_pk_bf16_f32 v65, v66, v67
  v_cvt_pk_bf16_f32 v66, v68, v69
  v_cvt_pk_bf16_f32 v67, v70, v71
  v_cvt_pk_bf16_f32 v68, v72, v73
  v_cvt_pk_bf16_f32 v69, v74, v75
  ds_write_b64 v1, v[64:65] offset:5632
  ds_write_b64 v1, v[66:67] offset:5648
  s_mov_b64 exec, s[70:71]
  ds_write_b64 v1, v[68:69] offset:5664
  s_mov_b64 exec, -1
  s_waitcnt lgkmcnt(0)
  s_barrier
  s_waitcnt vmcnt(0)
  ds_read_b128 v[8:11], v153
  ds_read_b128 v[12:15], v153 offset:64
  ds_read_b128 v[16:19], v153 offset:128
  s_waitcnt lgkmcnt(0)
  buffer_store_dwordx4 v[8:11], v154, s[48:51], s76 offen sc1
  buffer_store_dwordx4 v[12:15], v154, s[48:51], s77 offen sc1
  s_cmp_ge_u32 s3, 4
  s_cbranch_scc1 L_ost_60
  buffer_store_dwordx4 v[16:19], v154, s[48:51], s78 offen sc1
L_ost_60:
  v_cmp_ne_u32 vcc, s11, v163
  s_cbranch_vccnz L_hslow_61
  s_add_u32 s60, s86, 0
  buffer_load_dwordx4 v[88:91], v150, s[44:47], s60 offen sc1
  buffer_load_dwordx4 v[92:95], v151, s[44:47], s60 offen sc1
  s_add_u32 s60, s86, 1024
  buffer_load_dwordx4 v[96:99], v150, s[44:47], s60 offen sc1
  buffer_load_dwordx4 v[100:103], v151, s[44:47], s60 offen sc1
  s_add_u32 s60, s86, 2048
  buffer_load_dwordx4 v[104:107], v150, s[44:47], s60 offen sc1
  buffer_load_dwordx4 v[108:111], v151, s[44:47], s60 offen sc1
  v_mov_b32 v8, 0
  v_mov_b32 v9, 0
  v_mov_b32 v10, 0
  v_mov_b32 v11, 0
  v_mov_b32 v12, 0
  v_mov_b32 v13, 0
  v_mov_b32 v14, 0
  v_mov_b32 v15, 0
  v_mov_b32 v16, 0
  v_mov_b32 v17, 0
  v_mov_b32 v18, 0
  v_mov_b32 v19, 0
  v_mov_b32 v20, 0
  v_mov_b32 v21, 0
  v_mov_b32 v22, 0
  v_mov_b32 v23, 0
  v_mov_b32 v24, 0
  v_mov_b32 v25, 0
  v_mov_b32 v26, 0
  v_mov_b32 v27, 0
  v_mov_b32 v28, 0
  v_mov_b32 v29, 0
  v_mov_b32 v30, 0
  v_mov_b32 v31, 0
  v_mov_b32 v32, 0
  v_mov_b32 v33, 0
  v_mov_b32 v34, 0
  v_mov_b32 v35, 0
  v_mov_b32 v36, 0
  v_mov_b32 v37, 0
  v_mov_b32 v38, 0
  v_mov_b32 v39, 0
  v_mov_b32 v40, 0
  v_mov_b32 v41, 0
  v_mov_b32 v42, 0
  v_mov_b32 v43, 0
  v_mov_b32 v44, 0
  v_mov_b32 v45, 0
  v_mov_b32 v46, 0
  v_mov_b32 v47, 0
  s_waitcnt vmcnt(6)
  v_mov_b32 v1, s89
  v_mov_b32 v2, s11
  s_mov_b64 s[62:63], exec
  s_mov_b64 exec, 1
  global_store_dword v1, v2, s[36:37] sc1
  s_mov_b64 exec, s[62:63]
  s_add_u32 s60, s86, 3072
  buffer_load_dwordx4 v[112:115], v150, s[44:47], s60 offen sc1
  buffer_load_dwordx4 v[116:119], v151, s[44:47], s60 offen sc1
  s_add_u32 s60, s86, 4096
  buffer_load_dwordx4 v[120:123], v150, s[44:47], s60 offen sc1
  buffer_load_dwordx4 v[124:127], v151, s[44:47], s60 offen sc1
  s_branch L_hjoin_62
L_hslow_61:
  v_mov_b32 v8, 0
  v_mov_b32 v9, 0
  v_mov_b32 v10, 0
  v_mov_b32 v11, 0
  v_mov_b32 v12, 0
  v_mov_b32 v13, 0
  v_mov_b32 v14, 0
  v_mov_b32 v15, 0
  v_mov_b32 v16, 0
  v_mov_b32 v17, 0
  v_mov_b32 v18, 0
  v_mov_b32 v19, 0
  v_mov_b32 v20, 0
  v_mov_b32 v21, 0
  v_mov_b32 v22, 0
  v_mov_b32 v23, 0
  v_mov_b32 v24, 0
  v_mov_b32 v25, 0
  v_mov_b32 v26, 0
  v_mov_b32 v27, 0
  v_mov_b32 v28, 0
  v_mov_b32 v29, 0
  v_mov_b32 v30, 0
  v_mov_b32 v31, 0
  v_mov_b32 v32, 0
  v_mov_b32 v33, 0
  v_mov_b32 v34, 0
  v_mov_b32 v35, 0
  v_mov_b32 v36, 0
  v_mov_b32 v37, 0
  v_mov_b32 v38, 0
  v_mov_b32 v39, 0
  v_mov_b32 v40, 0
  v_mov_b32 v41, 0
  v_mov_b32 v42, 0
  v_mov_b32 v43, 0
  v_mov_b32 v44, 0
  v_mov_b32 v45, 0
  v_mov_b32 v46, 0
  v_mov_b32 v47, 0
  s_waitcnt vmcnt(0)
  v_mov_b32 v1, s89
  v_mov_b32 v2, s11
  s_mov_b64 s[62:63], exec
  s_mov_b64 exec, 1
  global_store_dword v1, v2, s[36:37] sc1
  s_mov_b64 exec, s[62:63]
  s_mov_b32 s64, 0
  s_waitcnt vmcnt(0)
  global_load_dword v7, v160, s[36:37] sc1
  s_sleep 4
  global_load_dword v163, v160, s[36:37] sc1
L_poll_63:
  s_waitcnt vmcnt(1)
  v_cmp_ne_u32 vcc, s11, v7
  s_cbranch_vccz L_polld_64
  s_sleep 6
  global_load_dword v7, v160, s[36:37] sc1
  s_waitcnt vmcnt(1)
  v_cmp_ne_u32 vcc, s11, v163
  s_cbranch_vccz L_polld_64
  s_sleep 6
  global_load_dword v163, v160, s[36:37] sc1
  s_add_u32 s64, s64, 1
  s_cmp_gt_u32 s64, 200000
  s_cbranch_scc0 L_poll_63
L_polld_64:
  s_waitcnt vmcnt(0)
  s_add_u32 s60, s86, 0
  buffer_load_dwordx4 v[88:91], v150, s[44:47], s60 offen sc1
  buffer_load_dwordx4 v[92:95], v151, s[44:47], s60 offen sc1
  s_add_u32 s60, s86, 1024
  buffer_load_dwordx4 v[96:99], v150, s[44:47], s60 offen sc1
  buffer_load_dwordx4 v[100:103], v151, s[44:47], s60 offen sc1
  s_add_u32 s60, s86, 2048
  buffer_load_dwordx4 v[104:107], v150, s[44:47], s60 offen sc1
  buffer_load_dwordx4 v[108:111], v151, s[44:47], s60 offen sc1
  s_add_u32 s60, s86, 3072
  buffer_load_dwordx4 v[112:115], v150, s[44:47], s60 offen sc1
  buffer_load_dwordx4 v[116:119], v151, s[44:47], s60 offen sc1
  s_add_u32 s60, s86, 4096
  buffer_load_dwordx4 v[120:123], v150, s[44:47], s60 offen sc1
  buffer_load_dwordx4 v[124:127], v151, s[44:47], s60 offen sc1
L_hjoin_62:
  s_barrier
  v_add_u32 v7, 0, v6
  ds_read_b128 v[48:51], v7 offset:0
  ds_read_b128 v[52:55], v7 offset:1024
  ds_read_b128 v[56:59], v7 offset:2048
  ds_read_b128 v[60:63], v7 offset:3072
  ds_read_b128 v[64:67], v7 offset:4096
  s_waitcnt vmcnt(8) lgkmcnt(0)
  v_mfma_f32_16x16x32_bf16 v[8:11], v[48:51], v[88:91], v[8:11]
  v_add_u32 v7, 5120, v6
  v_mfma_f32_16x16x32_bf16 v[28:31], v[48:51], v[92:95], v[28:31]
  ds_read_b128 v[68:71], v7 offset:0
  v_mfma_f32_16x16x32_bf16 v[12:15], v[52:55], v[88:91], v[12:15]
  ds_read_b128 v[72:75], v7 offset:1024
  v_mfma_f32_16x16x32_bf16 v[32:35], v[52:55], v[92:95], v[32:35]
  ds_read_b128 v[76:79], v7 offset:2048
  v_mfma_f32_16x16x32_bf16 v[16:19], v[56:59], v[88:91], v[16:19]
  ds_read_b128 v[80:83], v7 offset:3072
  v_mfma_f32_16x16x32_bf16 v[36:39], v[56:59], v[92:95], v[36:39]
  ds_read_b128 v[84:87], v7 offset:4096
  v_mfma_f32_16x16x32_bf16 v[20:23], v[60:63], v[88:91], v[20:23]
  v_mfma_f32_16x16x32_bf16 v[40:43], v[60:63], v[92:95], v[40:43]
  v_mfma_f32_16x16x32_bf16 v[24:27], v[64:67], v[88:91], v[24:27]
  v_mfma_f32_16x16x32_bf16 v[44:47], v[64:67], v[92:95], v[44:47]
  s_add_u32 s60, s86, 5120
  buffer_load_dwordx4 v[88:91], v150, s[44:47], s60 offen sc1
  buffer_load_dwordx4 v[92:95], v151, s[44:47], s60 offen sc1
  s_waitcnt lgkmcnt(0)
  s_waitcnt vmcnt(8)
  v_mfma_f32_16x16x32_bf16 v[8:11], v[68:71], v[96:99], v[8:11]
  v_add_u32 v7, 40960, v6
  v_mfma_f32_16x16x32_bf16 v[28:31], v[68:71], v[100:103], v[28:31]
  ds_read_b128 v[48:51], v7 offset:0
  v_mfma_f32_16x16x32_bf16 v[12:15], v[72:75], v[96:99], v[12:15]
  ds_read_b128 v[52:55], v7 offset:1024
  v_mfma_f32_16x16x32_bf16 v[32:35], v[72:75], v[100:103], v[32:35]
  ds_read_b128 v[56:59], v7 offset:2048
  v_mfma_f32_16x16x32_bf16 v[16:19], v[76:79], v[96:99], v[16:19]
  ds_read_b128 v[60:63], v7 offset:3072
  v_mfma_f32_16x16x32_bf16 v[36:39], v[76:79], v[100:103], v[36:39]
  ds_read_b128 v[64:67], v7 offset:4096
  v_mfma_f32_16x16x32_bf16 v[20:23], v[80:83], v[96:99], v[20:23]
  v_mfma_f32_16x16x32_bf16 v[40:43], v[80:83], v[100:103], v[40:43]
  v_mfma_f32_16x16x32_bf16 v[24:27], v[84:87], v[96:99], v[24:27]
  v_mfma_f32_16x16x32_bf16 v[44:47], v[84:87], v[100:103], v[44:47]
  s_add_u32 s60, s86, 6144
  buffer_load_dwordx4 v[96:99], v150, s[44:47], s60 offen sc1
  buffer_load_dwordx4 v[100:103], v151, s[44:47], s60 offen sc1
  s_waitcnt vmcnt(8) lgkmcnt(0)
  v_mfma_f32_16x16x32_bf16 v[8:11], v[48:51], v[104:107], v[8:11]
  v_add_u32 v7, 46080, v6
  v_mfma_f32_16x16x32_bf16 v[28:31], v[48:51], v[108:111], v[28:31]
  ds_read_b128 v[68:71], v7 offset:0
  v_mfma_f32_16x16x32_bf16 v[12:15], v[52:55], v[104:107], v[12:15]
  ds_read_b128 v[72:75], v7 offset:1024
  v_mfma_f32_16x16x32_bf16 v[32:35], v[52:55], v[108:111], v[32:35]
  ds_read_b128 v[76:79], v7 offset:2048
  v_mfma_f32_16x16x32_bf16 v[16:19], v[56:59], v[104:107], v[16:19]
  ds_read_b128 v[80:83], v7 offset:3072
  v_mfma_f32_16x16x32_bf16 v[36:39], v[56:59], v[108:111], v[36:39]
  ds_read_b128 v[84:87], v7 offset:4096
  v_mfma_f32_16x16x32_bf16 v[20:23], v[60:63], v[104:107], v[20:23]
  v_mfma_f32_16x16x32_bf16 v[40:43], v[60:63], v[108:111], v[40:43]
  v_mfma_f32_16x16x32_bf16 v[24:27], v[64:67], v[104:107], v[24:27]
  v_mfma_f32_16x16x32_bf16 v[44:47], v[64:67], v[108:111], v[44:47]
  s_add_u32 s60, s86, 7168
  buffer_load_dwordx4 v[104:107], v150, s[44:47], s60 offen sc1
  buffer_load_dwordx4 v[108:111], v151, s[44:47], s60 offen sc1
  s_waitcnt lgkmcnt(0)
  s_barrier
  s_waitcnt vmcnt(8)
  v_mfma_f32_16x16x32_bf16 v[8:11], v[68:71], v[112:115], v[8:11]
  v_add_u32 v7, 81920, v6
  v_mfma_f32_16x16x32_bf16 v[28:31], v[68:71], v[116:119], v[28:31]
  ds_read_b128 v[48:51], v7 offset:0
  v_mfma_f32_16x16x32_bf16 v[12:15], v[72:75], v[112:115], v[12:15]
  ds_read_b128 v[52:55], v7 offset:1024
  v_mfma_f32_16x16x32_bf16 v[32:35], v[72:75], v[116:119], v[32:35]
  ds_read_b128 v[56:59], v7 offset:2048
  v_mfma_f32_16x16x32_bf16 v[16:19], v[76:79], v[112:115], v[16:19]
  ds_read_b128 v[60:63], v7 offset:3072
  v_mfma_f32_16x16x32_bf16 v[36:39], v[76:79], v[116:119], v[36:39]
  ds_read_b128 v[64:67], v7 offset:4096
  v_mfma_f32_16x16x32_bf16 v[20:23], v[80:83], v[112:115], v[20:23]
  v_mfma_f32_16x16x32_bf16 v[40:43], v[80:83], v[116:119], v[40:43]
  v_mfma_f32_16x16x32_bf16 v[24:27], v[84:87], v[112:115], v[24:27]
  v_mfma_f32_16x16x32_bf16 v[44:47], v[84:87], v[116:119], v[44:47]
  s_add_u32 s60, s86, 8192
  buffer_load_dwordx4 v[112:115], v150, s[44:47], s60 offen sc1
  buffer_load_dwordx4 v[116:119], v151, s[44:47], s60 offen sc1
  s_waitcnt vmcnt(8) lgkmcnt(0)
  v_mfma_f32_16x16x32_bf16 v[8:11], v[48:51], v[120:123], v[8:11]
  v_add_u32 v7, 87040, v6
  v_mfma_f32_16x16x32_bf16 v[28:31], v[48:51], v[124:127], v[28:31]
  ds_read_b128 v[68:71], v7 offset:0
  v_mfma_f32_16x16x32_bf16 v[12:15], v[52:55], v[120:123], v[12:15]
  ds_read_b128 v[72:75], v7 offset:1024
  v_mfma_f32_16x16x32_bf16 v[32:35], v[52:55], v[124:127], v[32:35]
  ds_read_b128 v[76:79], v7 offset:2048
  v_mfma_f32_16x16x32_bf16 v[16:19], v[56:59], v[120:123], v[16:19]
  ds_read_b128 v[80:83], v7 offset:3072
  v_mfma_f32_16x16x32_bf16 v[36:39], v[56:59], v[124:127], v[36:39]
  ds_read_b128 v[84:87], v7 offset:4096
  v_mfma_f32_16x16x32_bf16 v[20:23], v[60:63], v[120:123], v[20:23]
  v_mfma_f32_16x16x32_bf16 v[40:43], v[60:63], v[124:127], v[40:43]
  v_mfma_f32_16x16x32_bf16 v[24:27], v[64:67], v[120:123], v[24:27]
  v_mfma_f32_16x16x32_bf16 v[44:47], v[64:67], v[124:127], v[44:47]
  s_add_u32 s60, s86, 9216
  buffer_load_dwordx4 v[120:123], v150, s[44:47], s60 offen sc1
  buffer_load_dwordx4 v[124:127], v151, s[44:47], s60 offen sc1
  s_waitcnt lgkmcnt(0)
  global_load_dword v152, v161, s[36:37] sc1
  s_waitcnt vmcnt(8)
  v_mfma_f32_16x16x32_bf16 v[8:11], v[68:71], v[88:91], v[8:11]
  v_add_u32 v7, 122880, v6
  v_mfma_f32_16x16x32_bf16 v[28:31], v[68:71], v[92:95], v[28:31]
  ds_read_b128 v[48:51], v7 offset:0
  v_mfma_f32_16x16x32_bf16 v[12:15], v[72:75], v[88:91], v[12:15]
  ds_read_b128 v[52:55], v7 offset:1024
  v_mfma_f32_16x16x32_bf16 v[32:35], v[72:75], v[92:95], v[32:35]
  ds_read_b128 v[56:59], v7 offset:2048
  v_mfma_f32_16x16x32_bf16 v[16:19], v[76:79], v[88:91], v[16:19]
  ds_read_b128 v[60:63], v7 offset:3072
  v_mfma_f32_16x16x32_bf16 v[36:39], v[76:79], v[92:95], v[36:39]
  ds_read_b128 v[64:67], v7 offset:4096
  v_mfma_f32_16x16x32_bf16 v[20:23], v[80:83], v[88:91], v[20:23]
  v_mfma_f32_16x16x32_bf16 v[40:43], v[80:83], v[92:95], v[40:43]
  v_mfma_f32_16x16x32_bf16 v[24:27], v[84:87], v[88:91], v[24:27]
  v_mfma_f32_16x16x32_bf16 v[44:47], v[84:87], v[92:95], v[44:47]
  s_add_u32 s60, s86, 10240
  buffer_load_dwordx4 v[88:91], v150, s[44:47], s60 offen sc1
  buffer_load_dwordx4 v[92:95], v151, s[44:47], s60 offen sc1
  s_waitcnt vmcnt(8) lgkmcnt(0)
  v_mfma_f32_16x16x32_bf16 v[8:11], v[48:51], v[96:99], v[8:11]
  v_add_u32 v7, 128000, v6
  v_mfma_f32_16x16x32_bf16 v[28:31], v[48:51], v[100:103], v[28:31]
  ds_read_b128 v[68:71], v7 offset:0
  v_mfma_f32_16x16x32_bf16 v[12:15], v[52:55], v[96:99], v[12:15]
  ds_read_b128 v[72:75], v7 offset:1024
  v_mfma_f32_16x16x32_bf16 v[32:35], v[52:55], v[100:103], v[32:35]
  ds_read_b128 v[76:79], v7 offset:2048
  v_mfma_f32_16x16x32_bf16 v[16:19], v[56:59], v[96:99], v[16:19]
  ds_read_b128 v[80:83], v7 offset:3072
  v_mfma_f32_16x16x32_bf16 v[36:39], v[56:59], v[100:103], v[36:39]
  ds_read_b128 v[84:87], v7 offset:4096
  v_mfma_f32_16x16x32_bf16 v[20:23], v[60:63], v[96:99], v[20:23]
  v_mfma_f32_16x16x32_bf16 v[40:43], v[60:63], v[100:103], v[40:43]
  v_mfma_f32_16x16x32_bf16 v[24:27], v[64:67], v[96:99], v[24:27]
  v_mfma_f32_16x16x32_bf16 v[44:47], v[64:67], v[100:103], v[44:47]
  s_add_u32 s60, s86, 11264
  buffer_load_dwordx4 v[96:99], v150, s[44:47], s60 offen sc1
  buffer_load_dwordx4 v[100:103], v151, s[44:47], s60 offen sc1
  s_waitcnt lgkmcnt(0)
  s_waitcnt vmcnt(4)
  v_cmp_ne_u32 vcc, s11, v152
  s_cbranch_vccz L_pp_65
  s_mov_b32 s64, 0
  s_waitcnt vmcnt(0)
  global_load_dword v7, v161, s[36:37] sc1
  s_sleep 4
  global_load_dword v152, v161, s[36:37] sc1
L_poll_66:
  s_waitcnt vmcnt(1)
  v_cmp_ne_u32 vcc, s11, v7
  s_cbranch_vccz L_polld_67
  s_sleep 6
  global_load_dword v7, v161, s[36:37] sc1
  s_waitcnt vmcnt(1)
  v_cmp_ne_u32 vcc, s11, v152
  s_cbranch_vccz L_polld_67
  s_sleep 6
  global_load_dword v152, v161, s[36:37] sc1
  s_add_u32 s64, s64, 1
  s_cmp_gt_u32 s64, 200000
  s_cbranch_scc0 L_poll_66
L_polld_67:
  s_waitcnt vmcnt(0)
L_pp_65:
  s_barrier
  s_waitcnt vmcnt(8)
  v_mfma_f32_16x16x32_bf16 v[8:11], v[68:71], v[104:107], v[8:11]
  v_add_u32 v7, 0, v6
  v_mfma_f32_16x16x32_bf16 v[28:31], v[68:71], v[108:111], v[28:31]
  ds_read_b128 v[48:51], v7 offset:0
  v_mfma_f32_16x16x32_bf16 v[12:15], v[72:75], v[104:107], v[12:15]
  ds_read_b128 v[52:55], v7 offset:1024
  v_mfma_f32_16x16x32_bf16 v[32:35], v[72:75], v[108:111], v[32:35]
  ds_read_b128 v[56:59], v7 offset:2048
  v_mfma_f32_16x16x32_bf16 v[16:19], v[76:79], v[104:107], v[16:19]
  ds_read_b128 v[60:63], v7 offset:3072
  v_mfma_f32_16x16x32_bf16 v[36:39], v[76:79], v[108:111], v[36:39]
  ds_read_b128 v[64:67], v7 offset:4096
  v_mfma_f32_16x16x32_bf16 v[20:23], v[80:83], v[104:107], v[20:23]
  v_mfma_f32_16x16x32_bf16 v[40:43], v[80:83], v[108:111], v[40:43]
  v_mfma_f32_16x16x32_bf16 v[24:27], v[84:87], v[104:107], v[24:27]
  v_mfma_f32_16x16x32_bf16 v[44:47], v[84:87], v[108:111], v[44:47]
  s_add_u32 s60, s87, 0
  buffer_load_dwordx4 v[104:107], v150, s[44:47], s60 offen sc1
  buffer_load_dwordx4 v[108:111], v151, s[44:47], s60 offen sc1
  s_waitcnt vmcnt(8) lgkmcnt(0)
  v_mfma_f32_16x16x32_bf16 v[8:11], v[48:51], v[112:115], v[8:11]
  v_add_u32 v7, 5120, v6
  v_mfma_f32_16x16x32_bf16 v[28:31], v[48:51], v[116:119], v[28:31]
  ds_read_b128 v[68:71], v7 offset:0
  v_mfma_f32_16x16x32_bf16 v[12:15], v[52:55], v[112:115], v[12:15]
  ds_read_b128 v[72:75], v7 offset:1024
  v_mfma_f32_16x16x32_bf16 v[32:35], v[52:55], v[116:119], v[32:35]
  ds_read_b128 v[76:79], v7 offset:2048
  v_mfma_f32_16x16x32_bf16 v[16:19], v[56:59], v[112:115], v[16:19]
  ds_read_b128 v[80:83], v7 offset:3072
  v_mfma_f32_16x16x32_bf16 v[36:39], v[56:59], v[116:119], v[36:39]
  ds_read_b128 v[84:87], v7 offset:4096
  v_mfma_f32_16x16x32_bf16 v[20:23], v[60:63], v[112:115], v[20:23]
  v_mfma_f32_16x16x32_bf16 v[40:43], v[60:63], v[116:119], v[40:43]
  v_mfma_f32_16x16x32_bf16 v[24:27], v[64:67], v[112:115], v[24:27]
  v_mfma_f32_16x16x32_bf16 v[44:47], v[64:67], v[116:119], v[44:47]
  s_add_u32 s60, s87, 1024
  buffer_load_dwordx4 v[112:115], v150, s[44:47], s60 offen sc1
  buffer_load_dwordx4 v[116:119], v151, s[44:47], s60 offen sc1
  s_waitcnt lgkmcnt(0)
  s_waitcnt vmcnt(8)
  v_mfma_f32_16x16x32_bf16 v[8:11], v[68:71], v[120:123], v[8:11]
  v_add_u32 v7, 40960, v6
  v_mfma_f32_16x16x32_bf16 v[28:31], v[68:71], v[124:127], v[28:31]
  ds_read_b128 v[48:51], v7 offset:0
  v_mfma_f32_16x16x32_bf16 v[12:15], v[72:75], v[120:123], v[12:15]
  ds_read_b128 v[52:55], v7 offset:1024
  v_mfma_f32_16x16x32_bf16 v[32:35], v[72:75], v[124:127], v[32:35]
  ds_read_b128 v[56:59], v7 offset:2048
  v_mfma_f32_16x16x32_bf16 v[16:19], v[76:79], v[120:123], v[16:19]
  ds_read_b128 v[60:63], v7 offset:3072
  v_mfma_f32_16x16x32_bf16 v[36:39], v[76:79], v[124:127], v[36:39]
  ds_read_b128 v[64:67], v7 offset:4096
  v_mfma_f32_16x16x32_bf16 v[20:23], v[80:83], v[120:123], v[20:23]
  v_mfma_f32_16x16x32_bf16 v[40:43], v[80:83], v[124:127], v[40:43]
  v_mfma_f32_16x16x32_bf16 v[24:27], v[84:87], v[120:123], v[24:27]
  v_mfma_f32_16x16x32_bf16 v[44:47], v[84:87], v[124:127], v[44:47]
  s_add_u32 s60, s87, 2048
  buffer_load_dwordx4 v[120:123], v150, s[44:47], s60 offen sc1
  buffer_load_dwordx4 v[124:127], v151, s[44:47], s60 offen sc1
  s_waitcnt vmcnt(8) lgkmcnt(0)
  v_mfma_f32_16x16x32_bf16 v[8:11], v[48:51], v[88:91], v[8:11]
  v_add_u32 v7, 46080, v6
  v_mfma_f32_16x16x32_bf16 v[28:31], v[48:51], v[92:95], v[28:31]
  ds_read_b128 v[68:71], v7 offset:0
  v_mfma_f32_16x16x32_bf16 v[12:15], v[52:55], v[88:91], v[12:15]
  ds_read_b128 v[72:75], v7 offset:1024
  v_mfma_f32_16x16x32_bf16 v[32:35], v[52:55], v[92:95], v[32:35]
  ds_read_b128 v[76:79], v7 offset:2048
  v_mfma_f32_16x16x32_bf16 v[16:19], v[56:59], v[88:91], v[16:19]
  ds_read_b128 v[80:83], v7 offset:3072
  v_mfma_f32_16x16x32_bf16 v[36:39], v[56:59], v[92:95], v[36:39]
  ds_read_b128 v[84:87], v7 offset:4096
  v_mfma_f32_16x16x32_bf16 v[20:23], v[60:63], v[88:91], v[20:23]
  v_mfma_f32_16x16x32_bf16 v[40:43], v[60:63], v[92:95], v[40:43]
  v_mfma_f32_16x16x32_bf16 v[24:27], v[64:67], v[88:91], v[24:27]
  v_mfma_f32_16x16x32_bf16 v[44:47], v[64:67], v[92:95], v[44:47]
  s_add_u32 s60, s87, 3072
  buffer_load_dwordx4 v[88:91], v150, s[44:47], s60 offen sc1
  buffer_load_dwordx4 v[92:95], v151, s[44:47], s60 offen sc1
  s_waitcnt lgkmcnt(0)
  s_barrier
  s_waitcnt vmcnt(8)
  v_mfma_f32_16x16x32_bf16 v[8:11], v[68:71], v[96:99], v[8:11]
  v_add_u32 v7, 81920, v6
  v_mfma_f32_16x16x32_bf16 v[28:31], v[68:71], v[100:103], v[28:31]
  ds_read_b128 v[48:51], v7 offset:0
  v_mfma_f32_16x16x32_bf16 v[12:15], v[72:75], v[96:99], v[12:15]
  ds_read_b128 v[52:55], v7 offset:1024
  v_mfma_f32_16x16x32_bf16 v[32:35], v[72:75], v[100:103], v[32:35]
  ds_read_b128 v[56:59], v7 offset:2048
  v_mfma_f32_16x16x32_bf16 v[16:19], v[76:79], v[96:99], v[16:19]
  ds_read_b128 v[60:63], v7 offset:3072
  v_mfma_f32_16x16x32_bf16 v[36:39], v[76:79], v[100:103], v[36:39]
  ds_read_b128 v[64:67], v7 offset:4096
  v_mfma_f32_16x16x32_bf16 v[20:23], v[80:83], v[96:99], v[20:23]
  v_mfma_f32_16x16x32_bf16 v[40:43], v[80:83], v[100:103], v[40:43]
  v_mfma_f32_16x16x32_bf16 v[24:27], v[84:87], v[96:99], v[24:27]
  v_mfma_f32_16x16x32_bf16 v[44:47], v[84:87], v[100:103], v[44:47]
  s_add_u32 s60, s87, 4096
  buffer_load_dwordx4 v[96:99], v150, s[44:47], s60 offen sc1
  buffer_load_dwordx4 v[100:103], v151, s[44:47], s60 offen sc1
  s_waitcnt vmcnt(8) lgkmcnt(0)
  v_mfma_f32_16x16x32_bf16 v[8:11], v[48:51], v[104:107], v[8:11]
  v_add_u32 v7, 87040, v6
  v_mfma_f32_16x16x32_bf16 v[28:31], v[48:51], v[108:111], v[28:31]
  ds_read_b128 v[68:71], v7 offset:0
  v_mfma_f32_16x16x32_bf16 v[12:15], v[52:55], v[104:107], v[12:15]
  ds_read_b128 v[72:75], v7 offset:1024
  v_mfma_f32_16x16x32_bf16 v[32:35], v[52:55], v[108:111], v[32:35]
  ds_read_b128 v[76:79], v7 offset:2048
  v_mfma_f32_16x16x32_bf16 v[16:19], v[56:59], v[104:107], v[16:19]
  ds_read_b128 v[80:83], v7 offset:3072
  v_mfma_f32_16x16x32_bf16 v[36:39], v[56:59], v[108:111], v[36:39]
  ds_read_b128 v[84:87], v7 offset:4096
  v_mfma_f32_16x16x32_bf16 v[20:23], v[60:63], v[104:107], v[20:23]
  v_mfma_f32_16x16x32_bf16 v[40:43], v[60:63], v[108:111], v[40:43]
  v_mfma_f32_16x16x32_bf16 v[24:27], v[64:67], v[104:107], v[24:27]
  v_mfma_f32_16x16x32_bf16 v[44:47], v[64:67], v[108:111], v[44:47]
  buffer_load_dwordx2 v[144:145], v4, s[52:55], s96 offen
  buffer_load_dwordx2 v[146:147], v4, s[52:55], s97 offen
  buffer_load_dwordx2 v[148:149], v4, s[52:55], s98 offen
  s_waitcnt lgkmcnt(0)
  s_waitcnt vmcnt(6)
  v_mfma_f32_16x16x32_bf16 v[8:11], v[68:71], v[112:115], v[8:11]
  v_add_u32 v7, 122880, v6
  v_mfma_f32_16x16x32_bf16 v[28:31], v[68:71], v[116:119], v[28:31]
  ds_read_b128 v[48:51], v7 offset:0
  v_mfma_f32_16x16x32_bf16 v[12:15], v[72:75], v[112:115], v[12:15]
  ds_read_b128 v[52:55], v7 offset:1024
  v_mfma_f32_16x16x32_bf16 v[32:35], v[72:75], v[116:119], v[32:35]
  ds_read_b128 v[56:59], v7 offset:2048
  v_mfma_f32_16x16x32_bf16 v[16:19], v[76:79], v[112:115], v[16:19]
  ds_read_b128 v[60:63], v7 offset:3072
  v_mfma_f32_16x16x32_bf16 v[36:39], v[76:79], v[116:119], v[36:39]
  ds_read_b128 v[64:67], v7 offset:4096
  v_mfma_f32_16x16x32_bf16 v[20:23], v[80:83], v[112:115], v[20:23]
  v_mfma_f32_16x16x32_bf16 v[40:43], v[80:83], v[116:119], v[40:43]
  v_mfma_f32_16x16x32_bf16 v[24:27], v[84:87], v[112:115], v[24:27]
  v_mfma_f32_16x16x32_bf16 v[44:47], v[84:87], v[116:119], v[44:47]
  s_waitcnt vmcnt(4) lgkmcnt(0)
  v_mfma_f32_16x16x32_bf16 v[8:11], v[48:51], v[120:123], v[8:11]
  v_add_u32 v7, 128000, v6
  v_mfma_f32_16x16x32_bf16 v[28:31], v[48:51], v[124:127], v[28:31]
  ds_read_b128 v[68:71], v7 offset:0
  v_mfma_f32_16x16x32_bf16 v[12:15], v[52:55], v[120:123], v[12:15]
  ds_read_b128 v[72:75], v7 offset:1024
  v_mfma_f32_16x16x32_bf16 v[32:35], v[52:55], v[124:127], v[32:35]
  ds_read_b128 v[76:79], v7 offset:2048
  v_mfma_f32_16x16x32_bf16 v[16:19], v[56:59], v[120:123], v[16:19]
  ds_read_b128 v[80:83], v7 offset:3072
  v_mfma_f32_16x16x32_bf16 v[36:39], v[56:59], v[124:127], v[36:39]
  ds_read_b128 v[84:87], v7 offset:4096
  v_mfma_f32_16x16x32_bf16 v[20:23], v[60:63], v[120:123], v[20:23]
  v_mfma_f32_16x16x32_bf16 v[40:43], v[60:63], v[124:127], v[40:43]
  v_mfma_f32_16x16x32_bf16 v[24:27], v[64:67], v[120:123], v[24:27]
  v_mfma_f32_16x16x32_bf16 v[44:47], v[64:67], v[124:127], v[44:47]
  s_waitcnt lgkmcnt(0)
  s_barrier
  s_waitcnt vmcnt(2)
  v_mfma_f32_16x16x32_bf16 v[8:11], v[68:71], v[88:91], v[8:11]
  v_add_u32 v7, 0, v6
  v_mfma_f32_16x16x32_bf16 v[28:31], v[68:71], v[92:95], v[28:31]
  ds_read_b128 v[48:51], v7 offset:0
  v_mfma_f32_16x16x32_bf16 v[12:15], v[72:75], v[88:91], v[12:15]
  ds_read_b128 v[52:55], v7 offset:1024
  v_mfma_f32_16x16x32_bf16 v[32:35], v[72:75], v[92:95], v[32:35]
  ds_read_b128 v[56:59], v7 offset:2048
  v_mfma_f32_16x16x32_bf16 v[16:19], v[76:79], v[88:91], v[16:19]
  ds_read_b128 v[60:63], v7 offset:3072
  v_mfma_f32_16x16x32_bf16 v[36:39], v[76:79], v[92:95], v[36:39]
  ds_read_b128 v[64:67], v7 offset:4096
  v_mfma_f32_16x16x32_bf16 v[20:23], v[80:83], v[88:91], v[20:23]
  v_mfma_f32_16x16x32_bf16 v[40:43], v[80:83], v[92:95], v[40:43]
  v_mfma_f32_16x16x32_bf16 v[24:27], v[84:87], v[88:91], v[24:27]
  v_mfma_f32_16x16x32_bf16 v[44:47], v[84:87], v[92:95], v[44:47]
  s_waitcnt vmcnt(0) lgkmcnt(0)
  v_mfma_f32_16x16x32_bf16 v[8:11], v[48:51], v[96:99], v[8:11]
  v_mfma_f32_16x16x32_bf16 v[28:31], v[48:51], v[100:103], v[28:31]
  v_mfma_f32_16x16x32_bf16 v[12:15], v[52:55], v[96:99], v[12:15]
  v_mfma_f32_16x16x32_bf16 v[32:35], v[52:55], v[100:103], v[32:35]
  v_mfma_f32_16x16x32_bf16 v[16:19], v[56:59], v[96:99], v[16:19]
  v_mfma_f32_16x16x32_bf16 v[36:39], v[56:59], v[100:103], v[36:39]
  v_mfma_f32_16x16x32_bf16 v[20:23], v[60:63], v[96:99], v[20:23]
  v_mfma_f32_16x16x32_bf16 v[40:43], v[60:63], v[100:103], v[40:43]
  v_mfma_f32_16x16x32_bf16 v[24:27], v[64:67], v[96:99], v[24:27]
  v_mfma_f32_16x16x32_bf16 v[44:47], v[64:67], v[100:103], v[44:47]
  s_mul_i32 s12, s9, 40960
  s_mul_i32 s13, s10, 10240
  s_add_u32 s12, s12, s13
  s_add_u32 s12, s12, 40960
  v_lshl_add_u32 v6, v0, 4, s12
  ds_write_b128 v6, v[8:11] offset:0
  ds_write_b128 v6, v[12:15] offset:1024
  ds_write_b128 v6, v[16:19] offset:2048
  ds_write_b128 v6, v[20:23] offset:3072
  ds_write_b128 v6, v[24:27] offset:4096
  ds_write_b128 v6, v[28:31] offset:5120
  ds_write_b128 v6, v[32:35] offset:6144
  ds_write_b128 v6, v[36:39] offset:7168
  ds_write_b128 v6, v[40:43] offset:8192
  ds_write_b128 v6, v[44:47] offset:9216
  s_mov_b32 s48, s32
  s_mov_b32 s49, s33
  s_mov_b32 s50, 2621440
  s_mov_b32 s51, 0x20000
  s_mul_i32 s12, s9, 40960
  s_lshl_b32 s13, s10, 10
  s_add_u32 s12, s12, s13
  s_add_u32 s12, s12, 40960
  v_lshl_add_u32 v6, v0, 4, s12
  s_waitcnt lgkmcnt(0)
  s_barrier
  ds_read_b128 v[48:51], v6 offset:0
  ds_read_b128 v[52:55], v6 offset:10240
  ds_read_b128 v[56:59], v6 offset:20480
  ds_read_b128 v[60:63], v6 offset:30720
  ds_read_b128 v[64:67], v6 offset:4096
  ds_read_b128 v[68:71], v6 offset:14336
  ds_read_b128 v[72:75], v6 offset:24576
  ds_read_b128 v[76:79], v6 offset:34816
  ds_read_b128 v[80:83], v6 offset:8192
  ds_read_b128 v[84:87], v6 offset:18432
  ds_read_b128 v[88:91], v6 offset:28672
  ds_read_b128 v[92:95], v6 offset:38912
  s_waitcnt lgkmcnt(8)
  v_pk_add_f32 v[48:49], v[48:49], v[52:53]
  v_pk_add_f32 v[56:57], v[56:57], v[60:61]
  v_pk_add_f32 v[50:51], v[50:51], v[54:55]
  v_pk_add_f32 v[58:59], v[58:59], v[62:63]
  v_lshlrev_b32 v52, 16, v144
  v_and_b32 v53, 0xffff0000, v144
  v_lshlrev_b32 v54, 16, v145
  v_and_b32 v55, 0xffff0000, v145
  v_pk_add_f32 v[48:49], v[48:49], v[56:57]
  v_pk_add_f32 v[50:51], v[50:51], v[58:59]
  v_pk_add_f32 v[48:49], v[48:49], v[52:53]
  v_pk_add_f32 v[50:51], v[50:51], v[54:55]
  v_cvt_pk_bf16_f32 v56, v48, v49
  v_cvt_pk_bf16_f32 v57, v50, v51
  buffer_store_dwordx2 v[56:57], v4, s[48:51], s96 offen
  s_waitcnt lgkmcnt(4)
  v_pk_add_f32 v[64:65], v[64:65], v[68:69]
  v_pk_add_f32 v[72:73], v[72:73], v[76:77]
  v_pk_add_f32 v[66:67], v[66:67], v[70:71]
  v_pk_add_f32 v[74:75], v[74:75], v[78:79]
  v_lshlrev_b32 v68, 16, v146
  v_and_b32 v69, 0xffff0000, v146
  v_lshlrev_b32 v70, 16, v147
  v_and_b32 v71, 0xffff0000, v147
  v_pk_add_f32 v[64:65], v[64:65], v[72:73]
  v_pk_add_f32 v[66:67], v[66:67], v[74:75]
  v_pk_add_f32 v[64:65], v[64:65], v[68:69]
  v_pk_add_f32 v[66:67], v[66:67], v[70:71]
  v_cvt_pk_bf16_f32 v72, v64, v65
  v_cvt_pk_bf16_f32 v73, v66, v67
  buffer_store_dwordx2 v[72:73], v4, s[48:51], s97 offen
  s_cmp_ge_u32 s10, 2
  s_cbranch_scc1 L_fin_70
  s_waitcnt lgkmcnt(0)
  v_pk_add_f32 v[80:81], v[80:81], v[84:85]
  v_pk_add_f32 v[88:89], v[88:89], v[92:93]
  v_pk_add_f32 v[82:83], v[82:83], v[86:87]
  v_pk_add_f32 v[90:91], v[90:91], v[94:95]
  v_lshlrev_b32 v84, 16, v148
  v_and_b32 v85, 0xffff0000, v148
  v_lshlrev_b32 v86, 16, v149
  v_and_b32 v87, 0xffff0000, v149
  v_pk_add_f32 v[80:81], v[80:81], v[88:89]
  v_pk_add_f32 v[82:83], v[82:83], v[90:91]
  v_pk_add_f32 v[80:81], v[80:81], v[84:85]
  v_pk_add_f32 v[82:83], v[82:83], v[86:87]
  v_cvt_pk_bf16_f32 v88, v80, v81
  v_cvt_pk_bf16_f32 v89, v82, v83
  buffer_store_dwordx2 v[88:89], v4, s[48:51], s98 offen
L_fin_70:
L_exit:
  s_endpgm
.section .rodata,"a"
.p2align 6
.amdhsa_kernel parallel_sum__linear_kernel_hedgehog__glu_gated_bilinear__prompt_kernel
  .amdhsa_next_free_vgpr 168
  .amdhsa_next_free_sgpr 100
  .amdhsa_accum_offset 168
  .amdhsa_group_segment_fixed_size 0
  .amdhsa_kernarg_size 88
  .amdhsa_user_sgpr_count 2
  .amdhsa_user_sgpr_kernarg_segment_ptr 1
  .amdhsa_system_sgpr_workgroup_id_x 1
  .amdhsa_float_denorm_mode_32 3
  .amdhsa_float_denorm_mode_16_64 3
.end_amdhsa_kernel
```
